```python
import torch

def _softmax(x, axis=-1):
    return torch.softmax(x, dim=axis)
def _gelu(x):
    return torch.nn.functional.gelu(x, approximate="tanh")
def _silu(x):
    return torch.nn.functional.silu(x)
def _sigmoid(x):
    return torch.sigmoid(x)
def _layernorm(x, axis=-1, eps=1e-5):
    m = x.mean(dim=axis, keepdim=True)
    v = x.var(dim=axis, keepdim=True, unbiased=False)
    return (x - m) / torch.sqrt(v + eps)
def _scatter_add(tgt, idx, src, axis=0):
    return tgt.clone().index_add_(axis, idx, src)
def _segment_sum(src, seg, n):
    out = torch.zeros((n,) + src.shape[1:], dtype=src.dtype)
    return out.index_add_(0, seg, src)
def _pad(x, pw):
    flat = tuple(v for pair in reversed(pw) for v in pair)
    return torch.nn.functional.pad(x, flat)

kernel_name = 'standalone__layernorm_linear__sampling'

def setup_inputs():

    _w = (lambda a: (lambda t: t.to(torch.bfloat16) if t.is_floating_point() else t)(torch.as_tensor(a)))
    B, S, D = 1024, 4, 1024
    return {
        "x": _w((lambda *s: torch.randn(*s, dtype=torch.bfloat16) * 0.05)(B, S, D)),
        "g": _w((lambda *s: torch.randn(*s, dtype=torch.bfloat16) * 0.05)(D) + 1.0),
        "b": _w((lambda *s: torch.randn(*s, dtype=torch.bfloat16) * 0.4)(D)),
        "w": _w((lambda *s: torch.randn(*s, dtype=torch.bfloat16) * 0.05)(D, D)),
    }

def reference(x, g, b, w):
    return (_layernorm(x, axis=-1) * g + b) @ w
```

```asm
; @launch grid=(256,1,1) block=(768,1,1) lds=163840
.amdgcn_target "amdgcn-amd-amdhsa--gfx950"
.text
.globl standalone__layernorm_linear__sampling_kernel
.p2align 8
.type standalone__layernorm_linear__sampling_kernel,@function
standalone__layernorm_linear__sampling_kernel:
    s_cmp_ge_u32 s2, 256
    s_cbranch_scc1 L_end
    s_load_dwordx8 s[4:11], s[0:1], 0
    s_load_dwordx4 s[12:15], s[0:1], 32
    s_load_dwordx2 s[56:57], s[0:1], 48
    v_lshrrev_b32 v48, 6, v0
    v_and_b32 v1, 63, v0
    v_readfirstlane_b32 s39, v48
    s_and_b32 s46, s2, 7
    s_lshr_b32 s47, s2, 3
    s_lshr_b32 s38, s47, 3
    s_lshl_b32 s36, s46, 2
    s_add_u32 s36, s36, s38
    s_and_b32 s37, s47, 7
    s_lshl_b32 s58, s38, 1
    s_add_u32 s58, s58, s37
    s_and_b32 s48, s46, 1
    s_add_u32 s58, s58, s48
    s_and_b32 s58, s58, 7
    s_lshr_b32 s42, s46, 1
    s_cmp_ge_u32 s39, 8
    s_cbranch_scc1 L_helpers
    s_and_b32 s40, s39, 3
    s_lshr_b32 s41, s39, 2
    s_lshl_b32 s44, s39, 13
    s_add_u32 s44, s44, 98304
    v_bfe_u32 v50, v1, 2, 2
    v_lshlrev_b32 v50, 5, v50
    v_lshrrev_b32 v49, 5, v1
    v_lshl_add_u32 v50, v49, 4, v50
    v_and_b32 v51, 3, v1
    v_lshl_add_u32 v3, v51, 2, v50
    s_lshl_b32 s45, s41, 10
    s_waitcnt lgkmcnt(0)
    s_mov_b32 s24, s6
    s_and_b32 s25, s7, 0xffff
    s_mov_b32 s26, 2048
    s_mov_b32 s27, 0x00020000
    s_add_u32 s46, s58, 0
    s_and_b32 s46, s46, 7
    s_lshl_b32 s46, s46, 7
    s_add_u32 s46, s46, s45
    buffer_load_dword v56, v3, s[24:27], s46 offen
    s_add_u32 s46, s58, 1
    s_and_b32 s46, s46, 7
    s_lshl_b32 s46, s46, 7
    s_add_u32 s46, s46, s45
    buffer_load_dword v57, v3, s[24:27], s46 offen
    s_add_u32 s46, s58, 2
    s_and_b32 s46, s46, 7
    s_lshl_b32 s46, s46, 7
    s_add_u32 s46, s46, s45
    buffer_load_dword v58, v3, s[24:27], s46 offen
    s_add_u32 s46, s58, 3
    s_and_b32 s46, s46, 7
    s_lshl_b32 s46, s46, 7
    s_add_u32 s46, s46, s45
    buffer_load_dword v59, v3, s[24:27], s46 offen
    s_add_u32 s46, s58, 4
    s_and_b32 s46, s46, 7
    s_lshl_b32 s46, s46, 7
    s_add_u32 s46, s46, s45
    buffer_load_dword v60, v3, s[24:27], s46 offen
    s_add_u32 s46, s58, 5
    s_and_b32 s46, s46, 7
    s_lshl_b32 s46, s46, 7
    s_add_u32 s46, s46, s45
    buffer_load_dword v61, v3, s[24:27], s46 offen
    s_add_u32 s46, s58, 6
    s_and_b32 s46, s46, 7
    s_lshl_b32 s46, s46, 7
    s_add_u32 s46, s46, s45
    buffer_load_dword v62, v3, s[24:27], s46 offen
    s_add_u32 s46, s58, 7
    s_and_b32 s46, s46, 7
    s_lshl_b32 s46, s46, 7
    s_add_u32 s46, s46, s45
    buffer_load_dword v63, v3, s[24:27], s46 offen
    s_mov_b32 s32, s12
    s_and_b32 s33, s13, 0xffff
    s_mov_b32 s34, 8388608
    s_mov_b32 s35, 0x00020000
    s_mov_b32 s28, s56
    s_and_b32 s29, s57, 0xffff
    s_mov_b32 s30, 2097152
    s_mov_b32 s31, 0x00020000
    v_and_b32 v48, 31, v1
    v_bfe_u32 v50, v1, 1, 3
    v_xor_b32 v50, v50, v49
    v_lshlrev_b32 v51, 7, v48
    v_lshl_add_u32 v51, v50, 4, v51
    v_add_u32 v4, s44, v51
    v_xor_b32 v5, 32, v4
    v_xor_b32 v6, 64, v4
    v_xor_b32 v7, 96, v4
    v_bfe_u32 v50, v1, 2, 2
    v_lshl_add_u32 v51, v49, 3, v50
    v_lshlrev_b32 v51, 8, v51
    v_bfe_u32 v52, v1, 4, 1
    v_lshl_add_u32 v51, v52, 5, v51
    v_and_b32 v52, 3, v1
    v_lshl_add_u32 v51, v52, 3, v51
    s_lshl_b32 s46, s41, 14
    v_add_u32 v51, s46, v51
    s_lshl_b32 s49, s41, 1
    s_xor_b32 s46, s49, 0
    v_xor_b32 v52, s46, v50
    v_lshl_add_u32 v8, v52, 6, v51
    v_add_u32 v12, 0x10000, v8
    s_xor_b32 s46, s49, 1
    v_xor_b32 v52, s46, v50
    v_lshl_add_u32 v9, v52, 6, v51
    v_add_u32 v13, 0x10000, v9
    s_xor_b32 s46, s49, 2
    v_xor_b32 v52, s46, v50
    v_lshl_add_u32 v10, v52, 6, v51
    v_add_u32 v14, 0x10000, v10
    s_xor_b32 s46, s49, 3
    v_xor_b32 v52, s46, v50
    v_lshl_add_u32 v11, v52, 6, v51
    v_add_u32 v15, 0x10000, v11
    v_accvgpr_write_b32 a0, 0
    v_mov_b32 v72, 0
    v_accvgpr_write_b32 a1, 0
    v_mov_b32 v73, 0
    v_accvgpr_write_b32 a2, 0
    v_mov_b32 v74, 0
    v_accvgpr_write_b32 a3, 0
    v_mov_b32 v75, 0
    v_accvgpr_write_b32 a4, 0
    v_mov_b32 v76, 0
    v_accvgpr_write_b32 a5, 0
    v_mov_b32 v77, 0
    v_accvgpr_write_b32 a6, 0
    v_mov_b32 v78, 0
    v_accvgpr_write_b32 a7, 0
    v_mov_b32 v79, 0
    v_accvgpr_write_b32 a8, 0
    v_mov_b32 v80, 0
    v_accvgpr_write_b32 a9, 0
    v_mov_b32 v81, 0
    v_accvgpr_write_b32 a10, 0
    v_mov_b32 v82, 0
    v_accvgpr_write_b32 a11, 0
    v_mov_b32 v83, 0
    v_accvgpr_write_b32 a12, 0
    v_mov_b32 v84, 0
    v_accvgpr_write_b32 a13, 0
    v_mov_b32 v85, 0
    v_accvgpr_write_b32 a14, 0
    v_mov_b32 v86, 0
    v_accvgpr_write_b32 a15, 0
    v_mov_b32 v87, 0
    v_accvgpr_write_b32 a16, 0
    v_mov_b32 v88, 0
    v_accvgpr_write_b32 a17, 0
    v_mov_b32 v89, 0
    v_accvgpr_write_b32 a18, 0
    v_mov_b32 v90, 0
    v_accvgpr_write_b32 a19, 0
    v_mov_b32 v91, 0
    v_accvgpr_write_b32 a20, 0
    v_mov_b32 v92, 0
    v_accvgpr_write_b32 a21, 0
    v_mov_b32 v93, 0
    v_accvgpr_write_b32 a22, 0
    v_mov_b32 v94, 0
    v_accvgpr_write_b32 a23, 0
    v_mov_b32 v95, 0
    v_accvgpr_write_b32 a24, 0
    v_mov_b32 v96, 0
    v_accvgpr_write_b32 a25, 0
    v_mov_b32 v97, 0
    v_accvgpr_write_b32 a26, 0
    v_mov_b32 v98, 0
    v_accvgpr_write_b32 a27, 0
    v_mov_b32 v99, 0
    v_accvgpr_write_b32 a28, 0
    v_mov_b32 v100, 0
    v_accvgpr_write_b32 a29, 0
    v_mov_b32 v101, 0
    v_accvgpr_write_b32 a30, 0
    v_mov_b32 v102, 0
    v_accvgpr_write_b32 a31, 0
    v_mov_b32 v103, 0
    v_lshlrev_b32 v64, 3, v48
    s_lshl_b32 s46, s36, 14
    s_lshl_b32 s47, s41, 3
    s_add_u32 s47, s47, s58
    s_lshl_b32 s47, s47, 10
    s_add_u32 s46, s46, s47
    s_lshl_b32 s47, s40, 8
    s_add_u32 s59, s46, s47
    v_mov_b32 v48, 0x3f803f80
    v_mov_b32 v49, 0
    v_mov_b32 v50, 0
    v_mov_b32 v51, 0
    v_mov_b32 v52, 0
    s_barrier
    ds_read_b128 v[20:23], v4 offset:0
    ds_read_b128 v[24:27], v5 offset:0
    ds_read_b128 v[28:31], v6 offset:0
    ds_read_b128 v[32:35], v7 offset:0
    s_waitcnt lgkmcnt(0)
    v_dot2_f32_bf16 v49, v20, v48, v49
    v_dot2_f32_bf16 v51, v20, v20, v51
    v_dot2_f32_bf16 v50, v21, v48, v50
    v_dot2_f32_bf16 v52, v21, v21, v52
    v_dot2_f32_bf16 v49, v22, v48, v49
    v_dot2_f32_bf16 v51, v22, v22, v51
    v_dot2_f32_bf16 v50, v23, v48, v50
    v_dot2_f32_bf16 v52, v23, v23, v52
    v_dot2_f32_bf16 v49, v24, v48, v49
    v_dot2_f32_bf16 v51, v24, v24, v51
    v_dot2_f32_bf16 v50, v25, v48, v50
    v_dot2_f32_bf16 v52, v25, v25, v52
    v_dot2_f32_bf16 v49, v26, v48, v49
    v_dot2_f32_bf16 v51, v26, v26, v51
    v_dot2_f32_bf16 v50, v27, v48, v50
    v_dot2_f32_bf16 v52, v27, v27, v52
    v_dot2_f32_bf16 v49, v28, v48, v49
    v_dot2_f32_bf16 v51, v28, v28, v51
    v_dot2_f32_bf16 v50, v29, v48, v50
    v_dot2_f32_bf16 v52, v29, v29, v52
    v_dot2_f32_bf16 v49, v30, v48, v49
    v_dot2_f32_bf16 v51, v30, v30, v51
    v_dot2_f32_bf16 v50, v31, v48, v50
    v_dot2_f32_bf16 v52, v31, v31, v52
    v_dot2_f32_bf16 v49, v32, v48, v49
    v_dot2_f32_bf16 v51, v32, v32, v51
    v_dot2_f32_bf16 v50, v33, v48, v50
    v_dot2_f32_bf16 v52, v33, v33, v52
    v_dot2_f32_bf16 v49, v34, v48, v49
    v_dot2_f32_bf16 v51, v34, v34, v51
    v_dot2_f32_bf16 v50, v35, v48, v50
    v_dot2_f32_bf16 v52, v35, v35, v52
    s_waitcnt vmcnt(0)
    v_lshlrev_b32 v16, 16, v56
    v_and_b32 v17, 0xffff0000, v56
    v_lshlrev_b32 v18, 16, v57
    v_and_b32 v19, 0xffff0000, v57
    v_add_f32 v49, v49, v50
    v_add_f32 v50, v51, v52
    v_mov_b32 v51, v49
    v_mov_b32 v52, v50
    s_nop 1
    v_permlane32_swap_b32 v51, v49
    v_permlane32_swap_b32 v52, v50
    s_nop 1
    v_add_f32 v66, v49, v51
    v_add_f32 v67, v50, v52
    v_mul_f32 v2, 0x3c800000, v66
    s_mov_b32 exec_hi, 0
    buffer_store_dwordx2 v[66:67], v64, s[28:31], s59 offen sc0 sc1
    s_mov_b64 exec, -1
    v_mul_f32 v48, v66, v66
    v_mul_f32 v49, 0x42000000, v67
    v_cmp_nle_f32 vcc, v48, v49
    s_cbranch_vccnz L_slowloop
    v_mov_b32 v2, 0
    s_barrier
    ds_read_b128 v[36:39], v4 offset:4096
    ds_read_b64_tr_b16 a[32:33], v8 offset:0
    ds_read_b64_tr_b16 a[34:35], v8 offset:1024
    ds_read_b64_tr_b16 a[36:37], v9 offset:0
    ds_read_b64_tr_b16 a[38:39], v9 offset:1024
    ds_read_b64_tr_b16 a[40:41], v10 offset:0
    ds_read_b64_tr_b16 a[42:43], v10 offset:1024
    ds_read_b64_tr_b16 a[44:45], v11 offset:0
    ds_read_b64_tr_b16 a[46:47], v11 offset:1024
    v_lshlrev_b32 v48, 16, v20
    v_and_b32 v49, 0xffff0000, v20
    v_lshlrev_b32 v50, 16, v21
    v_and_b32 v51, 0xffff0000, v21
    v_mul_f32_dpp v48, v16, v48 row_newbcast:0 row_mask:0xf bank_mask:0xf
    v_mul_f32_dpp v49, v17, v49 row_newbcast:0 row_mask:0xf bank_mask:0xf
    v_mul_f32_dpp v50, v16, v50 row_newbcast:1 row_mask:0xf bank_mask:0xf
    v_mul_f32_dpp v51, v17, v51 row_newbcast:1 row_mask:0xf bank_mask:0xf
    v_cvt_pk_bf16_f32 v40, v48, v49
    v_cvt_pk_bf16_f32 v41, v50, v51
    v_lshlrev_b32 v52, 16, v22
    v_and_b32 v53, 0xffff0000, v22
    v_lshlrev_b32 v54, 16, v23
    v_and_b32 v55, 0xffff0000, v23
    v_mul_f32_dpp v52, v16, v52 row_newbcast:2 row_mask:0xf bank_mask:0xf
    v_mul_f32_dpp v53, v17, v53 row_newbcast:2 row_mask:0xf bank_mask:0xf
    v_mul_f32_dpp v54, v16, v54 row_newbcast:3 row_mask:0xf bank_mask:0xf
    v_mul_f32_dpp v55, v17, v55 row_newbcast:3 row_mask:0xf bank_mask:0xf
    v_cvt_pk_bf16_f32 v42, v52, v53
    v_cvt_pk_bf16_f32 v43, v54, v55
    s_nop 1
    s_waitcnt lgkmcnt(0)
    s_setprio 0
    s_cmp_eq_u32 s41, 0
    s_cbranch_scc0 L_alf1
    s_setprio 1
L_alf1:
    v_mfma_f32_32x32x16_bf16 v[72:87], a[32:35], v[40:43], v[72:87]
    ds_read_b128 v[20:23], v5 offset:4096
    ds_read_b64_tr_b16 a[48:49], v8 offset:4096
    ds_read_b64_tr_b16 a[50:51], v8 offset:5120
    ds_read_b64_tr_b16 a[52:53], v9 offset:4096
    ds_read_b64_tr_b16 a[54:55], v9 offset:5120
    ds_read_b64_tr_b16 a[56:57], v10 offset:4096
    ds_read_b64_tr_b16 a[58:59], v10 offset:5120
    ds_read_b64_tr_b16 a[60:61], v11 offset:4096
    ds_read_b64_tr_b16 a[62:63], v11 offset:5120
    v_lshlrev_b32 v48, 16, v24
    v_and_b32 v49, 0xffff0000, v24
    v_lshlrev_b32 v50, 16, v25
    v_and_b32 v51, 0xffff0000, v25
    v_mul_f32_dpp v48, v16, v48 row_newbcast:4 row_mask:0xf bank_mask:0xf
    v_mul_f32_dpp v49, v17, v49 row_newbcast:4 row_mask:0xf bank_mask:0xf
    v_mul_f32_dpp v50, v16, v50 row_newbcast:5 row_mask:0xf bank_mask:0xf
    v_mfma_f32_32x32x16_bf16 v[88:103], a[36:39], v[40:43], v[88:103]
    v_mul_f32_dpp v51, v17, v51 row_newbcast:5 row_mask:0xf bank_mask:0xf
    v_cvt_pk_bf16_f32 v44, v48, v49
    v_cvt_pk_bf16_f32 v45, v50, v51
    v_lshlrev_b32 v52, 16, v26
    v_and_b32 v53, 0xffff0000, v26
    v_lshlrev_b32 v54, 16, v27
    v_and_b32 v55, 0xffff0000, v27
    v_mfma_f32_32x32x16_bf16 a[0:15], a[40:43], v[40:43], a[0:15]
    v_mul_f32_dpp v52, v16, v52 row_newbcast:6 row_mask:0xf bank_mask:0xf
    v_mul_f32_dpp v53, v17, v53 row_newbcast:6 row_mask:0xf bank_mask:0xf
    v_mul_f32_dpp v54, v16, v54 row_newbcast:7 row_mask:0xf bank_mask:0xf
    v_mul_f32_dpp v55, v17, v55 row_newbcast:7 row_mask:0xf bank_mask:0xf
    v_cvt_pk_bf16_f32 v46, v52, v53
    v_cvt_pk_bf16_f32 v47, v54, v55
    v_mfma_f32_32x32x16_bf16 a[16:31], a[44:47], v[40:43], a[16:31]
    s_waitcnt lgkmcnt(0)
    v_mfma_f32_32x32x16_bf16 v[72:87], a[48:51], v[44:47], v[72:87]
    ds_read_b128 v[24:27], v6 offset:4096
    ds_read_b64_tr_b16 a[32:33], v8 offset:8192
    ds_read_b64_tr_b16 a[34:35], v8 offset:9216
    ds_read_b64_tr_b16 a[36:37], v9 offset:8192
    ds_read_b64_tr_b16 a[38:39], v9 offset:9216
    ds_read_b64_tr_b16 a[40:41], v10 offset:8192
    ds_read_b64_tr_b16 a[42:43], v10 offset:9216
    ds_read_b64_tr_b16 a[44:45], v11 offset:8192
    ds_read_b64_tr_b16 a[46:47], v11 offset:9216
    v_lshlrev_b32 v48, 16, v28
    v_and_b32 v49, 0xffff0000, v28
    v_lshlrev_b32 v50, 16, v29
    v_and_b32 v51, 0xffff0000, v29
    v_mul_f32_dpp v48, v16, v48 row_newbcast:8 row_mask:0xf bank_mask:0xf
    v_mul_f32_dpp v49, v17, v49 row_newbcast:8 row_mask:0xf bank_mask:0xf
    v_mul_f32_dpp v50, v16, v50 row_newbcast:9 row_mask:0xf bank_mask:0xf
    v_mfma_f32_32x32x16_bf16 v[88:103], a[52:55], v[44:47], v[88:103]
    v_mul_f32_dpp v51, v17, v51 row_newbcast:9 row_mask:0xf bank_mask:0xf
    v_cvt_pk_bf16_f32 v40, v48, v49
    v_cvt_pk_bf16_f32 v41, v50, v51
    v_lshlrev_b32 v52, 16, v30
    v_and_b32 v53, 0xffff0000, v30
    v_lshlrev_b32 v54, 16, v31
    v_and_b32 v55, 0xffff0000, v31
    v_mfma_f32_32x32x16_bf16 a[0:15], a[56:59], v[44:47], a[0:15]
    v_mul_f32_dpp v52, v16, v52 row_newbcast:10 row_mask:0xf bank_mask:0xf
    v_mul_f32_dpp v53, v17, v53 row_newbcast:10 row_mask:0xf bank_mask:0xf
    v_mul_f32_dpp v54, v16, v54 row_newbcast:11 row_mask:0xf bank_mask:0xf
    v_mul_f32_dpp v55, v17, v55 row_newbcast:11 row_mask:0xf bank_mask:0xf
    v_cvt_pk_bf16_f32 v42, v52, v53
    v_cvt_pk_bf16_f32 v43, v54, v55
    v_mfma_f32_32x32x16_bf16 a[16:31], a[60:63], v[44:47], a[16:31]
    s_waitcnt lgkmcnt(0)
    s_setprio 0
    s_cmp_eq_u32 s41, 1
    s_cbranch_scc0 L_alf3
    s_setprio 1
L_alf3:
    v_mfma_f32_32x32x16_bf16 v[72:87], a[32:35], v[40:43], v[72:87]
    ds_read_b128 v[28:31], v7 offset:4096
    ds_read_b64_tr_b16 a[48:49], v8 offset:12288
    ds_read_b64_tr_b16 a[50:51], v8 offset:13312
    ds_read_b64_tr_b16 a[52:53], v9 offset:12288
    ds_read_b64_tr_b16 a[54:55], v9 offset:13312
    ds_read_b64_tr_b16 a[56:57], v10 offset:12288
    ds_read_b64_tr_b16 a[58:59], v10 offset:13312
    ds_read_b64_tr_b16 a[60:61], v11 offset:12288
    ds_read_b64_tr_b16 a[62:63], v11 offset:13312
    v_lshlrev_b32 v48, 16, v32
    v_and_b32 v49, 0xffff0000, v32
    v_lshlrev_b32 v50, 16, v33
    v_and_b32 v51, 0xffff0000, v33
    v_mul_f32_dpp v48, v16, v48 row_newbcast:12 row_mask:0xf bank_mask:0xf
    v_mul_f32_dpp v49, v17, v49 row_newbcast:12 row_mask:0xf bank_mask:0xf
    v_mul_f32_dpp v50, v16, v50 row_newbcast:13 row_mask:0xf bank_mask:0xf
    v_mfma_f32_32x32x16_bf16 v[88:103], a[36:39], v[40:43], v[88:103]
    v_mul_f32_dpp v51, v17, v51 row_newbcast:13 row_mask:0xf bank_mask:0xf
    v_cvt_pk_bf16_f32 v44, v48, v49
    v_cvt_pk_bf16_f32 v45, v50, v51
    v_lshlrev_b32 v52, 16, v34
    v_and_b32 v53, 0xffff0000, v34
    v_lshlrev_b32 v54, 16, v35
    v_and_b32 v55, 0xffff0000, v35
    v_mfma_f32_32x32x16_bf16 a[0:15], a[40:43], v[40:43], a[0:15]
    v_mul_f32_dpp v52, v16, v52 row_newbcast:14 row_mask:0xf bank_mask:0xf
    v_mul_f32_dpp v53, v17, v53 row_newbcast:14 row_mask:0xf bank_mask:0xf
    v_mul_f32_dpp v54, v16, v54 row_newbcast:15 row_mask:0xf bank_mask:0xf
    v_mul_f32_dpp v55, v17, v55 row_newbcast:15 row_mask:0xf bank_mask:0xf
    v_cvt_pk_bf16_f32 v46, v52, v53
    v_cvt_pk_bf16_f32 v47, v54, v55
    v_mfma_f32_32x32x16_bf16 a[16:31], a[44:47], v[40:43], a[16:31]
    s_waitcnt lgkmcnt(0)
    s_barrier
    v_mfma_f32_32x32x16_bf16 v[72:87], a[48:51], v[44:47], v[72:87]
    ds_read_b128 v[32:35], v4 offset:0
    ds_read_b64_tr_b16 a[32:33], v8 offset:32768
    ds_read_b64_tr_b16 a[34:35], v8 offset:33792
    ds_read_b64_tr_b16 a[36:37], v9 offset:32768
    ds_read_b64_tr_b16 a[38:39], v9 offset:33792
    ds_read_b64_tr_b16 a[40:41], v10 offset:32768
    ds_read_b64_tr_b16 a[42:43], v10 offset:33792
    ds_read_b64_tr_b16 a[44:45], v11 offset:32768
    ds_read_b64_tr_b16 a[46:47], v11 offset:33792
    v_lshlrev_b32 v48, 16, v36
    v_and_b32 v49, 0xffff0000, v36
    v_lshlrev_b32 v50, 16, v37
    v_and_b32 v51, 0xffff0000, v37
    v_mul_f32_dpp v48, v18, v48 row_newbcast:0 row_mask:0xf bank_mask:0xf
    v_mul_f32_dpp v49, v19, v49 row_newbcast:0 row_mask:0xf bank_mask:0xf
    v_mul_f32_dpp v50, v18, v50 row_newbcast:1 row_mask:0xf bank_mask:0xf
    v_mfma_f32_32x32x16_bf16 v[88:103], a[52:55], v[44:47], v[88:103]
    v_mul_f32_dpp v51, v19, v51 row_newbcast:1 row_mask:0xf bank_mask:0xf
    v_cvt_pk_bf16_f32 v40, v48, v49
    v_cvt_pk_bf16_f32 v41, v50, v51
    v_lshlrev_b32 v52, 16, v38
    v_and_b32 v53, 0xffff0000, v38
    v_lshlrev_b32 v54, 16, v39
    v_and_b32 v55, 0xffff0000, v39
    v_mfma_f32_32x32x16_bf16 a[0:15], a[56:59], v[44:47], a[0:15]
    v_mul_f32_dpp v52, v18, v52 row_newbcast:2 row_mask:0xf bank_mask:0xf
    v_mul_f32_dpp v53, v19, v53 row_newbcast:2 row_mask:0xf bank_mask:0xf
    v_mul_f32_dpp v54, v18, v54 row_newbcast:3 row_mask:0xf bank_mask:0xf
    v_mul_f32_dpp v55, v19, v55 row_newbcast:3 row_mask:0xf bank_mask:0xf
    v_cvt_pk_bf16_f32 v42, v52, v53
    v_cvt_pk_bf16_f32 v43, v54, v55
    v_mfma_f32_32x32x16_bf16 a[16:31], a[60:63], v[44:47], a[16:31]
    v_lshlrev_b32 v16, 16, v58
    v_and_b32 v17, 0xffff0000, v58
    s_waitcnt lgkmcnt(0)
    s_setprio 0
    s_cmp_eq_u32 s41, 0
    s_cbranch_scc0 L_alf5
    s_setprio 1
L_alf5:
    v_mfma_f32_32x32x16_bf16 v[72:87], a[32:35], v[40:43], v[72:87]
    ds_read_b128 v[36:39], v5 offset:0
    ds_read_b64_tr_b16 a[48:49], v8 offset:36864
    ds_read_b64_tr_b16 a[50:51], v8 offset:37888
    ds_read_b64_tr_b16 a[52:53], v9 offset:36864
    ds_read_b64_tr_b16 a[54:55], v9 offset:37888
    ds_read_b64_tr_b16 a[56:57], v10 offset:36864
    ds_read_b64_tr_b16 a[58:59], v10 offset:37888
    ds_read_b64_tr_b16 a[60:61], v11 offset:36864
    ds_read_b64_tr_b16 a[62:63], v11 offset:37888
    v_lshlrev_b32 v48, 16, v20
    v_and_b32 v49, 0xffff0000, v20
    v_lshlrev_b32 v50, 16, v21
    v_and_b32 v51, 0xffff0000, v21
    v_mul_f32_dpp v48, v18, v48 row_newbcast:4 row_mask:0xf bank_mask:0xf
    v_mul_f32_dpp v49, v19, v49 row_newbcast:4 row_mask:0xf bank_mask:0xf
    v_mul_f32_dpp v50, v18, v50 row_newbcast:5 row_mask:0xf bank_mask:0xf
    v_mfma_f32_32x32x16_bf16 v[88:103], a[36:39], v[40:43], v[88:103]
    v_mul_f32_dpp v51, v19, v51 row_newbcast:5 row_mask:0xf bank_mask:0xf
    v_cvt_pk_bf16_f32 v44, v48, v49
    v_cvt_pk_bf16_f32 v45, v50, v51
    v_lshlrev_b32 v52, 16, v22
    v_and_b32 v53, 0xffff0000, v22
    v_lshlrev_b32 v54, 16, v23
    v_and_b32 v55, 0xffff0000, v23
    v_mfma_f32_32x32x16_bf16 a[0:15], a[40:43], v[40:43], a[0:15]
    v_mul_f32_dpp v52, v18, v52 row_newbcast:6 row_mask:0xf bank_mask:0xf
    v_mul_f32_dpp v53, v19, v53 row_newbcast:6 row_mask:0xf bank_mask:0xf
    v_mul_f32_dpp v54, v18, v54 row_newbcast:7 row_mask:0xf bank_mask:0xf
    v_mul_f32_dpp v55, v19, v55 row_newbcast:7 row_mask:0xf bank_mask:0xf
    v_cvt_pk_bf16_f32 v46, v52, v53
    v_cvt_pk_bf16_f32 v47, v54, v55
    v_mfma_f32_32x32x16_bf16 a[16:31], a[44:47], v[40:43], a[16:31]
    s_waitcnt lgkmcnt(0)
    v_mfma_f32_32x32x16_bf16 v[72:87], a[48:51], v[44:47], v[72:87]
    ds_read_b128 v[20:23], v6 offset:0
    ds_read_b64_tr_b16 a[32:33], v8 offset:40960
    ds_read_b64_tr_b16 a[34:35], v8 offset:41984
    ds_read_b64_tr_b16 a[36:37], v9 offset:40960
    ds_read_b64_tr_b16 a[38:39], v9 offset:41984
    ds_read_b64_tr_b16 a[40:41], v10 offset:40960
    ds_read_b64_tr_b16 a[42:43], v10 offset:41984
    ds_read_b64_tr_b16 a[44:45], v11 offset:40960
    ds_read_b64_tr_b16 a[46:47], v11 offset:41984
    v_lshlrev_b32 v48, 16, v24
    v_and_b32 v49, 0xffff0000, v24
    v_lshlrev_b32 v50, 16, v25
    v_and_b32 v51, 0xffff0000, v25
    v_mul_f32_dpp v48, v18, v48 row_newbcast:8 row_mask:0xf bank_mask:0xf
    v_mul_f32_dpp v49, v19, v49 row_newbcast:8 row_mask:0xf bank_mask:0xf
    v_mul_f32_dpp v50, v18, v50 row_newbcast:9 row_mask:0xf bank_mask:0xf
    v_mfma_f32_32x32x16_bf16 v[88:103], a[52:55], v[44:47], v[88:103]
    v_mul_f32_dpp v51, v19, v51 row_newbcast:9 row_mask:0xf bank_mask:0xf
    v_cvt_pk_bf16_f32 v40, v48, v49
    v_cvt_pk_bf16_f32 v41, v50, v51
    v_lshlrev_b32 v52, 16, v26
    v_and_b32 v53, 0xffff0000, v26
    v_lshlrev_b32 v54, 16, v27
    v_and_b32 v55, 0xffff0000, v27
    v_mfma_f32_32x32x16_bf16 a[0:15], a[56:59], v[44:47], a[0:15]
    v_mul_f32_dpp v52, v18, v52 row_newbcast:10 row_mask:0xf bank_mask:0xf
    v_mul_f32_dpp v53, v19, v53 row_newbcast:10 row_mask:0xf bank_mask:0xf
    v_mul_f32_dpp v54, v18, v54 row_newbcast:11 row_mask:0xf bank_mask:0xf
    v_mul_f32_dpp v55, v19, v55 row_newbcast:11 row_mask:0xf bank_mask:0xf
    v_cvt_pk_bf16_f32 v42, v52, v53
    v_cvt_pk_bf16_f32 v43, v54, v55
    v_mfma_f32_32x32x16_bf16 a[16:31], a[60:63], v[44:47], a[16:31]
    s_waitcnt lgkmcnt(0)
    s_setprio 0
    s_cmp_eq_u32 s41, 1
    s_cbranch_scc0 L_alf7
    s_setprio 1
L_alf7:
    v_mfma_f32_32x32x16_bf16 v[72:87], a[32:35], v[40:43], v[72:87]
    ds_read_b128 v[24:27], v7 offset:0
    ds_read_b64_tr_b16 a[48:49], v8 offset:45056
    ds_read_b64_tr_b16 a[50:51], v8 offset:46080
    ds_read_b64_tr_b16 a[52:53], v9 offset:45056
    ds_read_b64_tr_b16 a[54:55], v9 offset:46080
    ds_read_b64_tr_b16 a[56:57], v10 offset:45056
    ds_read_b64_tr_b16 a[58:59], v10 offset:46080
    ds_read_b64_tr_b16 a[60:61], v11 offset:45056
    ds_read_b64_tr_b16 a[62:63], v11 offset:46080
    v_lshlrev_b32 v48, 16, v28
    v_and_b32 v49, 0xffff0000, v28
    v_lshlrev_b32 v50, 16, v29
    v_and_b32 v51, 0xffff0000, v29
    v_mul_f32_dpp v48, v18, v48 row_newbcast:12 row_mask:0xf bank_mask:0xf
    v_mul_f32_dpp v49, v19, v49 row_newbcast:12 row_mask:0xf bank_mask:0xf
    v_mul_f32_dpp v50, v18, v50 row_newbcast:13 row_mask:0xf bank_mask:0xf
    v_mfma_f32_32x32x16_bf16 v[88:103], a[36:39], v[40:43], v[88:103]
    v_mul_f32_dpp v51, v19, v51 row_newbcast:13 row_mask:0xf bank_mask:0xf
    v_cvt_pk_bf16_f32 v44, v48, v49
    v_cvt_pk_bf16_f32 v45, v50, v51
    v_lshlrev_b32 v52, 16, v30
    v_and_b32 v53, 0xffff0000, v30
    v_lshlrev_b32 v54, 16, v31
    v_and_b32 v55, 0xffff0000, v31
    v_mfma_f32_32x32x16_bf16 a[0:15], a[40:43], v[40:43], a[0:15]
    v_mul_f32_dpp v52, v18, v52 row_newbcast:14 row_mask:0xf bank_mask:0xf
    v_mul_f32_dpp v53, v19, v53 row_newbcast:14 row_mask:0xf bank_mask:0xf
    v_mul_f32_dpp v54, v18, v54 row_newbcast:15 row_mask:0xf bank_mask:0xf
    v_mul_f32_dpp v55, v19, v55 row_newbcast:15 row_mask:0xf bank_mask:0xf
    v_cvt_pk_bf16_f32 v46, v52, v53
    v_cvt_pk_bf16_f32 v47, v54, v55
    v_mfma_f32_32x32x16_bf16 a[16:31], a[44:47], v[40:43], a[16:31]
    s_waitcnt vmcnt(0) lgkmcnt(0)
    s_barrier
    v_mfma_f32_32x32x16_bf16 v[72:87], a[48:51], v[44:47], v[72:87]
    ds_read_b128 v[28:31], v4 offset:4096
    ds_read_b64_tr_b16 a[32:33], v12 offset:0
    ds_read_b64_tr_b16 a[34:35], v12 offset:1024
    ds_read_b64_tr_b16 a[36:37], v13 offset:0
    ds_read_b64_tr_b16 a[38:39], v13 offset:1024
    ds_read_b64_tr_b16 a[40:41], v14 offset:0
    ds_read_b64_tr_b16 a[42:43], v14 offset:1024
    ds_read_b64_tr_b16 a[44:45], v15 offset:0
    ds_read_b64_tr_b16 a[46:47], v15 offset:1024
    v_lshlrev_b32 v48, 16, v32
    v_and_b32 v49, 0xffff0000, v32
    v_lshlrev_b32 v50, 16, v33
    v_and_b32 v51, 0xffff0000, v33
    v_mul_f32_dpp v48, v16, v48 row_newbcast:0 row_mask:0xf bank_mask:0xf
    v_mul_f32_dpp v49, v17, v49 row_newbcast:0 row_mask:0xf bank_mask:0xf
    v_mul_f32_dpp v50, v16, v50 row_newbcast:1 row_mask:0xf bank_mask:0xf
    v_mfma_f32_32x32x16_bf16 v[88:103], a[52:55], v[44:47], v[88:103]
    v_mul_f32_dpp v51, v17, v51 row_newbcast:1 row_mask:0xf bank_mask:0xf
    v_cvt_pk_bf16_f32 v40, v48, v49
    v_cvt_pk_bf16_f32 v41, v50, v51
    v_lshlrev_b32 v52, 16, v34
    v_and_b32 v53, 0xffff0000, v34
    v_lshlrev_b32 v54, 16, v35
    v_and_b32 v55, 0xffff0000, v35
    v_mfma_f32_32x32x16_bf16 a[0:15], a[56:59], v[44:47], a[0:15]
    v_mul_f32_dpp v52, v16, v52 row_newbcast:2 row_mask:0xf bank_mask:0xf
    v_mul_f32_dpp v53, v17, v53 row_newbcast:2 row_mask:0xf bank_mask:0xf
    v_mul_f32_dpp v54, v16, v54 row_newbcast:3 row_mask:0xf bank_mask:0xf
    v_mul_f32_dpp v55, v17, v55 row_newbcast:3 row_mask:0xf bank_mask:0xf
    v_cvt_pk_bf16_f32 v42, v52, v53
    v_cvt_pk_bf16_f32 v43, v54, v55
    v_mfma_f32_32x32x16_bf16 a[16:31], a[60:63], v[44:47], a[16:31]
    v_lshlrev_b32 v18, 16, v59
    v_and_b32 v19, 0xffff0000, v59
    s_waitcnt lgkmcnt(0)
    s_setprio 0
    s_cmp_eq_u32 s41, 0
    s_cbranch_scc0 L_alf9
    s_setprio 1
L_alf9:
    v_mfma_f32_32x32x16_bf16 v[72:87], a[32:35], v[40:43], v[72:87]
    ds_read_b128 v[32:35], v5 offset:4096
    ds_read_b64_tr_b16 a[48:49], v12 offset:4096
    ds_read_b64_tr_b16 a[50:51], v12 offset:5120
    ds_read_b64_tr_b16 a[52:53], v13 offset:4096
    ds_read_b64_tr_b16 a[54:55], v13 offset:5120
    ds_read_b64_tr_b16 a[56:57], v14 offset:4096
    ds_read_b64_tr_b16 a[58:59], v14 offset:5120
    ds_read_b64_tr_b16 a[60:61], v15 offset:4096
    ds_read_b64_tr_b16 a[62:63], v15 offset:5120
    v_lshlrev_b32 v48, 16, v36
    v_and_b32 v49, 0xffff0000, v36
    v_lshlrev_b32 v50, 16, v37
    v_and_b32 v51, 0xffff0000, v37
    v_mul_f32_dpp v48, v16, v48 row_newbcast:4 row_mask:0xf bank_mask:0xf
    v_mul_f32_dpp v49, v17, v49 row_newbcast:4 row_mask:0xf bank_mask:0xf
    v_mul_f32_dpp v50, v16, v50 row_newbcast:5 row_mask:0xf bank_mask:0xf
    v_mfma_f32_32x32x16_bf16 v[88:103], a[36:39], v[40:43], v[88:103]
    v_mul_f32_dpp v51, v17, v51 row_newbcast:5 row_mask:0xf bank_mask:0xf
    v_cvt_pk_bf16_f32 v44, v48, v49
    v_cvt_pk_bf16_f32 v45, v50, v51
    v_lshlrev_b32 v52, 16, v38
    v_and_b32 v53, 0xffff0000, v38
    v_lshlrev_b32 v54, 16, v39
    v_and_b32 v55, 0xffff0000, v39
    v_mfma_f32_32x32x16_bf16 a[0:15], a[40:43], v[40:43], a[0:15]
    v_mul_f32_dpp v52, v16, v52 row_newbcast:6 row_mask:0xf bank_mask:0xf
    v_mul_f32_dpp v53, v17, v53 row_newbcast:6 row_mask:0xf bank_mask:0xf
    v_mul_f32_dpp v54, v16, v54 row_newbcast:7 row_mask:0xf bank_mask:0xf
    v_mul_f32_dpp v55, v17, v55 row_newbcast:7 row_mask:0xf bank_mask:0xf
    v_cvt_pk_bf16_f32 v46, v52, v53
    v_cvt_pk_bf16_f32 v47, v54, v55
    v_mfma_f32_32x32x16_bf16 a[16:31], a[44:47], v[40:43], a[16:31]
    s_waitcnt lgkmcnt(0)
    v_mfma_f32_32x32x16_bf16 v[72:87], a[48:51], v[44:47], v[72:87]
    ds_read_b128 v[36:39], v6 offset:4096
    ds_read_b64_tr_b16 a[32:33], v12 offset:8192
    ds_read_b64_tr_b16 a[34:35], v12 offset:9216
    ds_read_b64_tr_b16 a[36:37], v13 offset:8192
    ds_read_b64_tr_b16 a[38:39], v13 offset:9216
    ds_read_b64_tr_b16 a[40:41], v14 offset:8192
    ds_read_b64_tr_b16 a[42:43], v14 offset:9216
    ds_read_b64_tr_b16 a[44:45], v15 offset:8192
    ds_read_b64_tr_b16 a[46:47], v15 offset:9216
    v_lshlrev_b32 v48, 16, v20
    v_and_b32 v49, 0xffff0000, v20
    v_lshlrev_b32 v50, 16, v21
    v_and_b32 v51, 0xffff0000, v21
    v_mul_f32_dpp v48, v16, v48 row_newbcast:8 row_mask:0xf bank_mask:0xf
    v_mul_f32_dpp v49, v17, v49 row_newbcast:8 row_mask:0xf bank_mask:0xf
    v_mul_f32_dpp v50, v16, v50 row_newbcast:9 row_mask:0xf bank_mask:0xf
    v_mfma_f32_32x32x16_bf16 v[88:103], a[52:55], v[44:47], v[88:103]
    v_mul_f32_dpp v51, v17, v51 row_newbcast:9 row_mask:0xf bank_mask:0xf
    v_cvt_pk_bf16_f32 v40, v48, v49
    v_cvt_pk_bf16_f32 v41, v50, v51
    v_lshlrev_b32 v52, 16, v22
    v_and_b32 v53, 0xffff0000, v22
    v_lshlrev_b32 v54, 16, v23
    v_and_b32 v55, 0xffff0000, v23
    v_mfma_f32_32x32x16_bf16 a[0:15], a[56:59], v[44:47], a[0:15]
    v_mul_f32_dpp v52, v16, v52 row_newbcast:10 row_mask:0xf bank_mask:0xf
    v_mul_f32_dpp v53, v17, v53 row_newbcast:10 row_mask:0xf bank_mask:0xf
    v_mul_f32_dpp v54, v16, v54 row_newbcast:11 row_mask:0xf bank_mask:0xf
    v_mul_f32_dpp v55, v17, v55 row_newbcast:11 row_mask:0xf bank_mask:0xf
    v_cvt_pk_bf16_f32 v42, v52, v53
    v_cvt_pk_bf16_f32 v43, v54, v55
    v_mfma_f32_32x32x16_bf16 a[16:31], a[60:63], v[44:47], a[16:31]
    s_waitcnt lgkmcnt(0)
    s_setprio 0
    s_cmp_eq_u32 s41, 1
    s_cbranch_scc0 L_alf11
    s_setprio 1
L_alf11:
    v_mfma_f32_32x32x16_bf16 v[72:87], a[32:35], v[40:43], v[72:87]
    ds_read_b128 v[20:23], v7 offset:4096
    ds_read_b64_tr_b16 a[48:49], v12 offset:12288
    ds_read_b64_tr_b16 a[50:51], v12 offset:13312
    ds_read_b64_tr_b16 a[52:53], v13 offset:12288
    ds_read_b64_tr_b16 a[54:55], v13 offset:13312
    ds_read_b64_tr_b16 a[56:57], v14 offset:12288
    ds_read_b64_tr_b16 a[58:59], v14 offset:13312
    ds_read_b64_tr_b16 a[60:61], v15 offset:12288
    ds_read_b64_tr_b16 a[62:63], v15 offset:13312
    v_lshlrev_b32 v48, 16, v24
    v_and_b32 v49, 0xffff0000, v24
    v_lshlrev_b32 v50, 16, v25
    v_and_b32 v51, 0xffff0000, v25
    v_mul_f32_dpp v48, v16, v48 row_newbcast:12 row_mask:0xf bank_mask:0xf
    v_mul_f32_dpp v49, v17, v49 row_newbcast:12 row_mask:0xf bank_mask:0xf
    v_mul_f32_dpp v50, v16, v50 row_newbcast:13 row_mask:0xf bank_mask:0xf
    v_mfma_f32_32x32x16_bf16 v[88:103], a[36:39], v[40:43], v[88:103]
    v_mul_f32_dpp v51, v17, v51 row_newbcast:13 row_mask:0xf bank_mask:0xf
    v_cvt_pk_bf16_f32 v44, v48, v49
    v_cvt_pk_bf16_f32 v45, v50, v51
    v_lshlrev_b32 v52, 16, v26
    v_and_b32 v53, 0xffff0000, v26
    v_lshlrev_b32 v54, 16, v27
    v_and_b32 v55, 0xffff0000, v27
    v_mfma_f32_32x32x16_bf16 a[0:15], a[40:43], v[40:43], a[0:15]
    v_mul_f32_dpp v52, v16, v52 row_newbcast:14 row_mask:0xf bank_mask:0xf
    v_mul_f32_dpp v53, v17, v53 row_newbcast:14 row_mask:0xf bank_mask:0xf
    v_mul_f32_dpp v54, v16, v54 row_newbcast:15 row_mask:0xf bank_mask:0xf
    v_mul_f32_dpp v55, v17, v55 row_newbcast:15 row_mask:0xf bank_mask:0xf
    v_cvt_pk_bf16_f32 v46, v52, v53
    v_cvt_pk_bf16_f32 v47, v54, v55
    v_mfma_f32_32x32x16_bf16 a[16:31], a[44:47], v[40:43], a[16:31]
    s_waitcnt lgkmcnt(0)
    s_barrier
    v_mfma_f32_32x32x16_bf16 v[72:87], a[48:51], v[44:47], v[72:87]
    ds_read_b128 v[24:27], v4 offset:0
    ds_read_b64_tr_b16 a[32:33], v8 offset:0
    ds_read_b64_tr_b16 a[34:35], v8 offset:1024
    ds_read_b64_tr_b16 a[36:37], v9 offset:0
    ds_read_b64_tr_b16 a[38:39], v9 offset:1024
    ds_read_b64_tr_b16 a[40:41], v10 offset:0
    ds_read_b64_tr_b16 a[42:43], v10 offset:1024
    ds_read_b64_tr_b16 a[44:45], v11 offset:0
    ds_read_b64_tr_b16 a[46:47], v11 offset:1024
    v_lshlrev_b32 v48, 16, v28
    v_and_b32 v49, 0xffff0000, v28
    v_lshlrev_b32 v50, 16, v29
    v_and_b32 v51, 0xffff0000, v29
    v_mul_f32_dpp v48, v18, v48 row_newbcast:0 row_mask:0xf bank_mask:0xf
    v_mul_f32_dpp v49, v19, v49 row_newbcast:0 row_mask:0xf bank_mask:0xf
    v_mul_f32_dpp v50, v18, v50 row_newbcast:1 row_mask:0xf bank_mask:0xf
    v_mfma_f32_32x32x16_bf16 v[88:103], a[52:55], v[44:47], v[88:103]
    v_mul_f32_dpp v51, v19, v51 row_newbcast:1 row_mask:0xf bank_mask:0xf
    v_cvt_pk_bf16_f32 v40, v48, v49
    v_cvt_pk_bf16_f32 v41, v50, v51
    v_lshlrev_b32 v52, 16, v30
    v_and_b32 v53, 0xffff0000, v30
    v_lshlrev_b32 v54, 16, v31
    v_and_b32 v55, 0xffff0000, v31
    v_mfma_f32_32x32x16_bf16 a[0:15], a[56:59], v[44:47], a[0:15]
    v_mul_f32_dpp v52, v18, v52 row_newbcast:2 row_mask:0xf bank_mask:0xf
    v_mul_f32_dpp v53, v19, v53 row_newbcast:2 row_mask:0xf bank_mask:0xf
    v_mul_f32_dpp v54, v18, v54 row_newbcast:3 row_mask:0xf bank_mask:0xf
    v_mul_f32_dpp v55, v19, v55 row_newbcast:3 row_mask:0xf bank_mask:0xf
    v_cvt_pk_bf16_f32 v42, v52, v53
    v_cvt_pk_bf16_f32 v43, v54, v55
    v_mfma_f32_32x32x16_bf16 a[16:31], a[60:63], v[44:47], a[16:31]
    v_lshlrev_b32 v16, 16, v60
    v_and_b32 v17, 0xffff0000, v60
    s_waitcnt lgkmcnt(0)
    s_setprio 0
    s_cmp_eq_u32 s41, 0
    s_cbranch_scc0 L_alf13
    s_setprio 1
L_alf13:
    v_mfma_f32_32x32x16_bf16 v[72:87], a[32:35], v[40:43], v[72:87]
    ds_read_b128 v[28:31], v5 offset:0
    ds_read_b64_tr_b16 a[48:49], v8 offset:4096
    ds_read_b64_tr_b16 a[50:51], v8 offset:5120
    ds_read_b64_tr_b16 a[52:53], v9 offset:4096
    ds_read_b64_tr_b16 a[54:55], v9 offset:5120
    ds_read_b64_tr_b16 a[56:57], v10 offset:4096
    ds_read_b64_tr_b16 a[58:59], v10 offset:5120
    ds_read_b64_tr_b16 a[60:61], v11 offset:4096
    ds_read_b64_tr_b16 a[62:63], v11 offset:5120
    v_lshlrev_b32 v48, 16, v32
    v_and_b32 v49, 0xffff0000, v32
    v_lshlrev_b32 v50, 16, v33
    v_and_b32 v51, 0xffff0000, v33
    v_mul_f32_dpp v48, v18, v48 row_newbcast:4 row_mask:0xf bank_mask:0xf
    v_mul_f32_dpp v49, v19, v49 row_newbcast:4 row_mask:0xf bank_mask:0xf
    v_mul_f32_dpp v50, v18, v50 row_newbcast:5 row_mask:0xf bank_mask:0xf
    v_mfma_f32_32x32x16_bf16 v[88:103], a[36:39], v[40:43], v[88:103]
    v_mul_f32_dpp v51, v19, v51 row_newbcast:5 row_mask:0xf bank_mask:0xf
    v_cvt_pk_bf16_f32 v44, v48, v49
    v_cvt_pk_bf16_f32 v45, v50, v51
    v_lshlrev_b32 v52, 16, v34
    v_and_b32 v53, 0xffff0000, v34
    v_lshlrev_b32 v54, 16, v35
    v_and_b32 v55, 0xffff0000, v35
    v_mfma_f32_32x32x16_bf16 a[0:15], a[40:43], v[40:43], a[0:15]
    v_mul_f32_dpp v52, v18, v52 row_newbcast:6 row_mask:0xf bank_mask:0xf
    v_mul_f32_dpp v53, v19, v53 row_newbcast:6 row_mask:0xf bank_mask:0xf
    v_mul_f32_dpp v54, v18, v54 row_newbcast:7 row_mask:0xf bank_mask:0xf
    v_mul_f32_dpp v55, v19, v55 row_newbcast:7 row_mask:0xf bank_mask:0xf
    v_cvt_pk_bf16_f32 v46, v52, v53
    v_cvt_pk_bf16_f32 v47, v54, v55
    v_mfma_f32_32x32x16_bf16 a[16:31], a[44:47], v[40:43], a[16:31]
    s_waitcnt lgkmcnt(0)
    v_mfma_f32_32x32x16_bf16 v[72:87], a[48:51], v[44:47], v[72:87]
    ds_read_b128 v[32:35], v6 offset:0
    ds_read_b64_tr_b16 a[32:33], v8 offset:8192
    ds_read_b64_tr_b16 a[34:35], v8 offset:9216
    ds_read_b64_tr_b16 a[36:37], v9 offset:8192
    ds_read_b64_tr_b16 a[38:39], v9 offset:9216
    ds_read_b64_tr_b16 a[40:41], v10 offset:8192
    ds_read_b64_tr_b16 a[42:43], v10 offset:9216
    ds_read_b64_tr_b16 a[44:45], v11 offset:8192
    ds_read_b64_tr_b16 a[46:47], v11 offset:9216
    v_lshlrev_b32 v48, 16, v36
    v_and_b32 v49, 0xffff0000, v36
    v_lshlrev_b32 v50, 16, v37
    v_and_b32 v51, 0xffff0000, v37
    v_mul_f32_dpp v48, v18, v48 row_newbcast:8 row_mask:0xf bank_mask:0xf
    v_mul_f32_dpp v49, v19, v49 row_newbcast:8 row_mask:0xf bank_mask:0xf
    v_mul_f32_dpp v50, v18, v50 row_newbcast:9 row_mask:0xf bank_mask:0xf
    v_mfma_f32_32x32x16_bf16 v[88:103], a[52:55], v[44:47], v[88:103]
    v_mul_f32_dpp v51, v19, v51 row_newbcast:9 row_mask:0xf bank_mask:0xf
    v_cvt_pk_bf16_f32 v40, v48, v49
    v_cvt_pk_bf16_f32 v41, v50, v51
    v_lshlrev_b32 v52, 16, v38
    v_and_b32 v53, 0xffff0000, v38
    v_lshlrev_b32 v54, 16, v39
    v_and_b32 v55, 0xffff0000, v39
    v_mfma_f32_32x32x16_bf16 a[0:15], a[56:59], v[44:47], a[0:15]
    v_mul_f32_dpp v52, v18, v52 row_newbcast:10 row_mask:0xf bank_mask:0xf
    v_mul_f32_dpp v53, v19, v53 row_newbcast:10 row_mask:0xf bank_mask:0xf
    v_mul_f32_dpp v54, v18, v54 row_newbcast:11 row_mask:0xf bank_mask:0xf
    v_mul_f32_dpp v55, v19, v55 row_newbcast:11 row_mask:0xf bank_mask:0xf
    v_cvt_pk_bf16_f32 v42, v52, v53
    v_cvt_pk_bf16_f32 v43, v54, v55
    v_mfma_f32_32x32x16_bf16 a[16:31], a[60:63], v[44:47], a[16:31]
    s_waitcnt lgkmcnt(0)
    s_setprio 0
    s_cmp_eq_u32 s41, 1
    s_cbranch_scc0 L_alf15
    s_setprio 1
L_alf15:
    v_mfma_f32_32x32x16_bf16 v[72:87], a[32:35], v[40:43], v[72:87]
    ds_read_b128 v[36:39], v7 offset:0
    ds_read_b64_tr_b16 a[48:49], v8 offset:12288
    ds_read_b64_tr_b16 a[50:51], v8 offset:13312
    ds_read_b64_tr_b16 a[52:53], v9 offset:12288
    ds_read_b64_tr_b16 a[54:55], v9 offset:13312
    ds_read_b64_tr_b16 a[56:57], v10 offset:12288
    ds_read_b64_tr_b16 a[58:59], v10 offset:13312
    ds_read_b64_tr_b16 a[60:61], v11 offset:12288
    ds_read_b64_tr_b16 a[62:63], v11 offset:13312
    v_lshlrev_b32 v48, 16, v20
    v_and_b32 v49, 0xffff0000, v20
    v_lshlrev_b32 v50, 16, v21
    v_and_b32 v51, 0xffff0000, v21
    v_mul_f32_dpp v48, v18, v48 row_newbcast:12 row_mask:0xf bank_mask:0xf
    v_mul_f32_dpp v49, v19, v49 row_newbcast:12 row_mask:0xf bank_mask:0xf
    v_mul_f32_dpp v50, v18, v50 row_newbcast:13 row_mask:0xf bank_mask:0xf
    v_mfma_f32_32x32x16_bf16 v[88:103], a[36:39], v[40:43], v[88:103]
    v_mul_f32_dpp v51, v19, v51 row_newbcast:13 row_mask:0xf bank_mask:0xf
    v_cvt_pk_bf16_f32 v44, v48, v49
    v_cvt_pk_bf16_f32 v45, v50, v51
    v_lshlrev_b32 v52, 16, v22
    v_and_b32 v53, 0xffff0000, v22
    v_lshlrev_b32 v54, 16, v23
    v_and_b32 v55, 0xffff0000, v23
    v_mfma_f32_32x32x16_bf16 a[0:15], a[40:43], v[40:43], a[0:15]
    v_mul_f32_dpp v52, v18, v52 row_newbcast:14 row_mask:0xf bank_mask:0xf
    v_mul_f32_dpp v53, v19, v53 row_newbcast:14 row_mask:0xf bank_mask:0xf
    v_mul_f32_dpp v54, v18, v54 row_newbcast:15 row_mask:0xf bank_mask:0xf
    v_mul_f32_dpp v55, v19, v55 row_newbcast:15 row_mask:0xf bank_mask:0xf
    v_cvt_pk_bf16_f32 v46, v52, v53
    v_cvt_pk_bf16_f32 v47, v54, v55
    v_mfma_f32_32x32x16_bf16 a[16:31], a[44:47], v[40:43], a[16:31]
    s_waitcnt lgkmcnt(0)
    s_barrier
    v_mfma_f32_32x32x16_bf16 v[72:87], a[48:51], v[44:47], v[72:87]
    ds_read_b128 v[20:23], v4 offset:4096
    ds_read_b64_tr_b16 a[32:33], v8 offset:32768
    ds_read_b64_tr_b16 a[34:35], v8 offset:33792
    ds_read_b64_tr_b16 a[36:37], v9 offset:32768
    ds_read_b64_tr_b16 a[38:39], v9 offset:33792
    ds_read_b64_tr_b16 a[40:41], v10 offset:32768
    ds_read_b64_tr_b16 a[42:43], v10 offset:33792
    ds_read_b64_tr_b16 a[44:45], v11 offset:32768
    ds_read_b64_tr_b16 a[46:47], v11 offset:33792
    v_lshlrev_b32 v48, 16, v24
    v_and_b32 v49, 0xffff0000, v24
    v_lshlrev_b32 v50, 16, v25
    v_and_b32 v51, 0xffff0000, v25
    v_mul_f32_dpp v48, v16, v48 row_newbcast:0 row_mask:0xf bank_mask:0xf
    v_mul_f32_dpp v49, v17, v49 row_newbcast:0 row_mask:0xf bank_mask:0xf
    v_mul_f32_dpp v50, v16, v50 row_newbcast:1 row_mask:0xf bank_mask:0xf
    v_mfma_f32_32x32x16_bf16 v[88:103], a[52:55], v[44:47], v[88:103]
    v_mul_f32_dpp v51, v17, v51 row_newbcast:1 row_mask:0xf bank_mask:0xf
    v_cvt_pk_bf16_f32 v40, v48, v49
    v_cvt_pk_bf16_f32 v41, v50, v51
    v_lshlrev_b32 v52, 16, v26
    v_and_b32 v53, 0xffff0000, v26
    v_lshlrev_b32 v54, 16, v27
    v_and_b32 v55, 0xffff0000, v27
    v_mfma_f32_32x32x16_bf16 a[0:15], a[56:59], v[44:47], a[0:15]
    v_mul_f32_dpp v52, v16, v52 row_newbcast:2 row_mask:0xf bank_mask:0xf
    v_mul_f32_dpp v53, v17, v53 row_newbcast:2 row_mask:0xf bank_mask:0xf
    v_mul_f32_dpp v54, v16, v54 row_newbcast:3 row_mask:0xf bank_mask:0xf
    v_mul_f32_dpp v55, v17, v55 row_newbcast:3 row_mask:0xf bank_mask:0xf
    v_cvt_pk_bf16_f32 v42, v52, v53
    v_cvt_pk_bf16_f32 v43, v54, v55
    v_mfma_f32_32x32x16_bf16 a[16:31], a[60:63], v[44:47], a[16:31]
    v_lshlrev_b32 v18, 16, v61
    v_and_b32 v19, 0xffff0000, v61
    s_waitcnt lgkmcnt(0)
    s_setprio 0
    s_cmp_eq_u32 s41, 0
    s_cbranch_scc0 L_alf17
    s_setprio 1
L_alf17:
    v_mfma_f32_32x32x16_bf16 v[72:87], a[32:35], v[40:43], v[72:87]
    ds_read_b128 v[24:27], v5 offset:4096
    ds_read_b64_tr_b16 a[48:49], v8 offset:36864
    ds_read_b64_tr_b16 a[50:51], v8 offset:37888
    ds_read_b64_tr_b16 a[52:53], v9 offset:36864
    ds_read_b64_tr_b16 a[54:55], v9 offset:37888
    ds_read_b64_tr_b16 a[56:57], v10 offset:36864
    ds_read_b64_tr_b16 a[58:59], v10 offset:37888
    ds_read_b64_tr_b16 a[60:61], v11 offset:36864
    ds_read_b64_tr_b16 a[62:63], v11 offset:37888
    v_lshlrev_b32 v48, 16, v28
    v_and_b32 v49, 0xffff0000, v28
    v_lshlrev_b32 v50, 16, v29
    v_and_b32 v51, 0xffff0000, v29
    v_mul_f32_dpp v48, v16, v48 row_newbcast:4 row_mask:0xf bank_mask:0xf
    v_mul_f32_dpp v49, v17, v49 row_newbcast:4 row_mask:0xf bank_mask:0xf
    v_mul_f32_dpp v50, v16, v50 row_newbcast:5 row_mask:0xf bank_mask:0xf
    v_mfma_f32_32x32x16_bf16 v[88:103], a[36:39], v[40:43], v[88:103]
    v_mul_f32_dpp v51, v17, v51 row_newbcast:5 row_mask:0xf bank_mask:0xf
    v_cvt_pk_bf16_f32 v44, v48, v49
    v_cvt_pk_bf16_f32 v45, v50, v51
    v_lshlrev_b32 v52, 16, v30
    v_and_b32 v53, 0xffff0000, v30
    v_lshlrev_b32 v54, 16, v31
    v_and_b32 v55, 0xffff0000, v31
    v_mfma_f32_32x32x16_bf16 a[0:15], a[40:43], v[40:43], a[0:15]
    v_mul_f32_dpp v52, v16, v52 row_newbcast:6 row_mask:0xf bank_mask:0xf
    v_mul_f32_dpp v53, v17, v53 row_newbcast:6 row_mask:0xf bank_mask:0xf
    v_mul_f32_dpp v54, v16, v54 row_newbcast:7 row_mask:0xf bank_mask:0xf
    v_mul_f32_dpp v55, v17, v55 row_newbcast:7 row_mask:0xf bank_mask:0xf
    v_cvt_pk_bf16_f32 v46, v52, v53
    v_cvt_pk_bf16_f32 v47, v54, v55
    v_mfma_f32_32x32x16_bf16 a[16:31], a[44:47], v[40:43], a[16:31]
    s_waitcnt lgkmcnt(0)
    v_mfma_f32_32x32x16_bf16 v[72:87], a[48:51], v[44:47], v[72:87]
    ds_read_b128 v[28:31], v6 offset:4096
    ds_read_b64_tr_b16 a[32:33], v8 offset:40960
    ds_read_b64_tr_b16 a[34:35], v8 offset:41984
    ds_read_b64_tr_b16 a[36:37], v9 offset:40960
    ds_read_b64_tr_b16 a[38:39], v9 offset:41984
    ds_read_b64_tr_b16 a[40:41], v10 offset:40960
    ds_read_b64_tr_b16 a[42:43], v10 offset:41984
    ds_read_b64_tr_b16 a[44:45], v11 offset:40960
    ds_read_b64_tr_b16 a[46:47], v11 offset:41984
    v_lshlrev_b32 v48, 16, v32
    v_and_b32 v49, 0xffff0000, v32
    v_lshlrev_b32 v50, 16, v33
    v_and_b32 v51, 0xffff0000, v33
    v_mul_f32_dpp v48, v16, v48 row_newbcast:8 row_mask:0xf bank_mask:0xf
    v_mul_f32_dpp v49, v17, v49 row_newbcast:8 row_mask:0xf bank_mask:0xf
    v_mul_f32_dpp v50, v16, v50 row_newbcast:9 row_mask:0xf bank_mask:0xf
    v_mfma_f32_32x32x16_bf16 v[88:103], a[52:55], v[44:47], v[88:103]
    v_mul_f32_dpp v51, v17, v51 row_newbcast:9 row_mask:0xf bank_mask:0xf
    v_cvt_pk_bf16_f32 v40, v48, v49
    v_cvt_pk_bf16_f32 v41, v50, v51
    v_lshlrev_b32 v52, 16, v34
    v_and_b32 v53, 0xffff0000, v34
    v_lshlrev_b32 v54, 16, v35
    v_and_b32 v55, 0xffff0000, v35
    v_mfma_f32_32x32x16_bf16 a[0:15], a[56:59], v[44:47], a[0:15]
    v_mul_f32_dpp v52, v16, v52 row_newbcast:10 row_mask:0xf bank_mask:0xf
    v_mul_f32_dpp v53, v17, v53 row_newbcast:10 row_mask:0xf bank_mask:0xf
    v_mul_f32_dpp v54, v16, v54 row_newbcast:11 row_mask:0xf bank_mask:0xf
    v_mul_f32_dpp v55, v17, v55 row_newbcast:11 row_mask:0xf bank_mask:0xf
    v_cvt_pk_bf16_f32 v42, v52, v53
    v_cvt_pk_bf16_f32 v43, v54, v55
    v_mfma_f32_32x32x16_bf16 a[16:31], a[60:63], v[44:47], a[16:31]
    s_waitcnt lgkmcnt(0)
    s_setprio 0
    s_cmp_eq_u32 s41, 1
    s_cbranch_scc0 L_alf19
    s_setprio 1
L_alf19:
    v_mfma_f32_32x32x16_bf16 v[72:87], a[32:35], v[40:43], v[72:87]
    ds_read_b128 v[32:35], v7 offset:4096
    ds_read_b64_tr_b16 a[48:49], v8 offset:45056
    ds_read_b64_tr_b16 a[50:51], v8 offset:46080
    ds_read_b64_tr_b16 a[52:53], v9 offset:45056
    ds_read_b64_tr_b16 a[54:55], v9 offset:46080
    ds_read_b64_tr_b16 a[56:57], v10 offset:45056
    ds_read_b64_tr_b16 a[58:59], v10 offset:46080
    ds_read_b64_tr_b16 a[60:61], v11 offset:45056
    ds_read_b64_tr_b16 a[62:63], v11 offset:46080
    v_lshlrev_b32 v48, 16, v36
    v_and_b32 v49, 0xffff0000, v36
    v_lshlrev_b32 v50, 16, v37
    v_and_b32 v51, 0xffff0000, v37
    v_mul_f32_dpp v48, v16, v48 row_newbcast:12 row_mask:0xf bank_mask:0xf
    v_mul_f32_dpp v49, v17, v49 row_newbcast:12 row_mask:0xf bank_mask:0xf
    v_mul_f32_dpp v50, v16, v50 row_newbcast:13 row_mask:0xf bank_mask:0xf
    v_mfma_f32_32x32x16_bf16 v[88:103], a[36:39], v[40:43], v[88:103]
    v_mul_f32_dpp v51, v17, v51 row_newbcast:13 row_mask:0xf bank_mask:0xf
    v_cvt_pk_bf16_f32 v44, v48, v49
    v_cvt_pk_bf16_f32 v45, v50, v51
    v_lshlrev_b32 v52, 16, v38
    v_and_b32 v53, 0xffff0000, v38
    v_lshlrev_b32 v54, 16, v39
    v_and_b32 v55, 0xffff0000, v39
    v_mfma_f32_32x32x16_bf16 a[0:15], a[40:43], v[40:43], a[0:15]
    v_mul_f32_dpp v52, v16, v52 row_newbcast:14 row_mask:0xf bank_mask:0xf
    v_mul_f32_dpp v53, v17, v53 row_newbcast:14 row_mask:0xf bank_mask:0xf
    v_mul_f32_dpp v54, v16, v54 row_newbcast:15 row_mask:0xf bank_mask:0xf
    v_mul_f32_dpp v55, v17, v55 row_newbcast:15 row_mask:0xf bank_mask:0xf
    v_cvt_pk_bf16_f32 v46, v52, v53
    v_cvt_pk_bf16_f32 v47, v54, v55
    v_mfma_f32_32x32x16_bf16 a[16:31], a[44:47], v[40:43], a[16:31]
    s_waitcnt lgkmcnt(0)
    s_barrier
    v_mfma_f32_32x32x16_bf16 v[72:87], a[48:51], v[44:47], v[72:87]
    ds_read_b128 v[36:39], v4 offset:0
    ds_read_b64_tr_b16 a[32:33], v12 offset:0
    ds_read_b64_tr_b16 a[34:35], v12 offset:1024
    ds_read_b64_tr_b16 a[36:37], v13 offset:0
    ds_read_b64_tr_b16 a[38:39], v13 offset:1024
    ds_read_b64_tr_b16 a[40:41], v14 offset:0
    ds_read_b64_tr_b16 a[42:43], v14 offset:1024
    ds_read_b64_tr_b16 a[44:45], v15 offset:0
    ds_read_b64_tr_b16 a[46:47], v15 offset:1024
    v_lshlrev_b32 v48, 16, v20
    v_and_b32 v49, 0xffff0000, v20
    v_lshlrev_b32 v50, 16, v21
    v_and_b32 v51, 0xffff0000, v21
    v_mul_f32_dpp v48, v18, v48 row_newbcast:0 row_mask:0xf bank_mask:0xf
    v_mul_f32_dpp v49, v19, v49 row_newbcast:0 row_mask:0xf bank_mask:0xf
    v_mul_f32_dpp v50, v18, v50 row_newbcast:1 row_mask:0xf bank_mask:0xf
    v_mfma_f32_32x32x16_bf16 v[88:103], a[52:55], v[44:47], v[88:103]
    v_mul_f32_dpp v51, v19, v51 row_newbcast:1 row_mask:0xf bank_mask:0xf
    v_cvt_pk_bf16_f32 v40, v48, v49
    v_cvt_pk_bf16_f32 v41, v50, v51
    v_lshlrev_b32 v52, 16, v22
    v_and_b32 v53, 0xffff0000, v22
    v_lshlrev_b32 v54, 16, v23
    v_and_b32 v55, 0xffff0000, v23
    v_mfma_f32_32x32x16_bf16 a[0:15], a[56:59], v[44:47], a[0:15]
    v_mul_f32_dpp v52, v18, v52 row_newbcast:2 row_mask:0xf bank_mask:0xf
    v_mul_f32_dpp v53, v19, v53 row_newbcast:2 row_mask:0xf bank_mask:0xf
    v_mul_f32_dpp v54, v18, v54 row_newbcast:3 row_mask:0xf bank_mask:0xf
    v_mul_f32_dpp v55, v19, v55 row_newbcast:3 row_mask:0xf bank_mask:0xf
    v_cvt_pk_bf16_f32 v42, v52, v53
    v_cvt_pk_bf16_f32 v43, v54, v55
    v_mfma_f32_32x32x16_bf16 a[16:31], a[60:63], v[44:47], a[16:31]
    v_lshlrev_b32 v16, 16, v62
    v_and_b32 v17, 0xffff0000, v62
    s_waitcnt lgkmcnt(0)
    s_setprio 0
    s_cmp_eq_u32 s41, 0
    s_cbranch_scc0 L_alf21
    s_setprio 1
L_alf21:
    v_mfma_f32_32x32x16_bf16 v[72:87], a[32:35], v[40:43], v[72:87]
    ds_read_b128 v[20:23], v5 offset:0
    ds_read_b64_tr_b16 a[48:49], v12 offset:4096
    ds_read_b64_tr_b16 a[50:51], v12 offset:5120
    ds_read_b64_tr_b16 a[52:53], v13 offset:4096
    ds_read_b64_tr_b16 a[54:55], v13 offset:5120
    ds_read_b64_tr_b16 a[56:57], v14 offset:4096
    ds_read_b64_tr_b16 a[58:59], v14 offset:5120
    ds_read_b64_tr_b16 a[60:61], v15 offset:4096
    ds_read_b64_tr_b16 a[62:63], v15 offset:5120
    v_lshlrev_b32 v48, 16, v24
    v_and_b32 v49, 0xffff0000, v24
    v_lshlrev_b32 v50, 16, v25
    v_and_b32 v51, 0xffff0000, v25
    v_mul_f32_dpp v48, v18, v48 row_newbcast:4 row_mask:0xf bank_mask:0xf
    v_mul_f32_dpp v49, v19, v49 row_newbcast:4 row_mask:0xf bank_mask:0xf
    v_mul_f32_dpp v50, v18, v50 row_newbcast:5 row_mask:0xf bank_mask:0xf
    v_mfma_f32_32x32x16_bf16 v[88:103], a[36:39], v[40:43], v[88:103]
    v_mul_f32_dpp v51, v19, v51 row_newbcast:5 row_mask:0xf bank_mask:0xf
    v_cvt_pk_bf16_f32 v44, v48, v49
    v_cvt_pk_bf16_f32 v45, v50, v51
    v_lshlrev_b32 v52, 16, v26
    v_and_b32 v53, 0xffff0000, v26
    v_lshlrev_b32 v54, 16, v27
    v_and_b32 v55, 0xffff0000, v27
    v_mfma_f32_32x32x16_bf16 a[0:15], a[40:43], v[40:43], a[0:15]
    v_mul_f32_dpp v52, v18, v52 row_newbcast:6 row_mask:0xf bank_mask:0xf
    v_mul_f32_dpp v53, v19, v53 row_newbcast:6 row_mask:0xf bank_mask:0xf
    v_mul_f32_dpp v54, v18, v54 row_newbcast:7 row_mask:0xf bank_mask:0xf
    v_mul_f32_dpp v55, v19, v55 row_newbcast:7 row_mask:0xf bank_mask:0xf
    v_cvt_pk_bf16_f32 v46, v52, v53
    v_cvt_pk_bf16_f32 v47, v54, v55
    v_mfma_f32_32x32x16_bf16 a[16:31], a[44:47], v[40:43], a[16:31]
    s_waitcnt lgkmcnt(0)
    v_mfma_f32_32x32x16_bf16 v[72:87], a[48:51], v[44:47], v[72:87]
    ds_read_b128 v[24:27], v6 offset:0
    ds_read_b64_tr_b16 a[32:33], v12 offset:8192
    ds_read_b64_tr_b16 a[34:35], v12 offset:9216
    ds_read_b64_tr_b16 a[36:37], v13 offset:8192
    ds_read_b64_tr_b16 a[38:39], v13 offset:9216
    ds_read_b64_tr_b16 a[40:41], v14 offset:8192
    ds_read_b64_tr_b16 a[42:43], v14 offset:9216
    ds_read_b64_tr_b16 a[44:45], v15 offset:8192
    ds_read_b64_tr_b16 a[46:47], v15 offset:9216
    v_lshlrev_b32 v48, 16, v28
    v_and_b32 v49, 0xffff0000, v28
    v_lshlrev_b32 v50, 16, v29
    v_and_b32 v51, 0xffff0000, v29
    v_mul_f32_dpp v48, v18, v48 row_newbcast:8 row_mask:0xf bank_mask:0xf
    v_mul_f32_dpp v49, v19, v49 row_newbcast:8 row_mask:0xf bank_mask:0xf
    v_mul_f32_dpp v50, v18, v50 row_newbcast:9 row_mask:0xf bank_mask:0xf
    v_mfma_f32_32x32x16_bf16 v[88:103], a[52:55], v[44:47], v[88:103]
    v_mul_f32_dpp v51, v19, v51 row_newbcast:9 row_mask:0xf bank_mask:0xf
    v_cvt_pk_bf16_f32 v40, v48, v49
    v_cvt_pk_bf16_f32 v41, v50, v51
    v_lshlrev_b32 v52, 16, v30
    v_and_b32 v53, 0xffff0000, v30
    v_lshlrev_b32 v54, 16, v31
    v_and_b32 v55, 0xffff0000, v31
    v_mfma_f32_32x32x16_bf16 a[0:15], a[56:59], v[44:47], a[0:15]
    v_mul_f32_dpp v52, v18, v52 row_newbcast:10 row_mask:0xf bank_mask:0xf
    v_mul_f32_dpp v53, v19, v53 row_newbcast:10 row_mask:0xf bank_mask:0xf
    v_mul_f32_dpp v54, v18, v54 row_newbcast:11 row_mask:0xf bank_mask:0xf
    v_mul_f32_dpp v55, v19, v55 row_newbcast:11 row_mask:0xf bank_mask:0xf
    v_cvt_pk_bf16_f32 v42, v52, v53
    v_cvt_pk_bf16_f32 v43, v54, v55
    v_mfma_f32_32x32x16_bf16 a[16:31], a[60:63], v[44:47], a[16:31]
    s_waitcnt lgkmcnt(0)
    s_setprio 0
    s_cmp_eq_u32 s41, 1
    s_cbranch_scc0 L_alf23
    s_setprio 1
L_alf23:
    v_mfma_f32_32x32x16_bf16 v[72:87], a[32:35], v[40:43], v[72:87]
    ds_read_b128 v[28:31], v7 offset:0
    ds_read_b64_tr_b16 a[48:49], v12 offset:12288
    ds_read_b64_tr_b16 a[50:51], v12 offset:13312
    ds_read_b64_tr_b16 a[52:53], v13 offset:12288
    ds_read_b64_tr_b16 a[54:55], v13 offset:13312
    ds_read_b64_tr_b16 a[56:57], v14 offset:12288
    ds_read_b64_tr_b16 a[58:59], v14 offset:13312
    ds_read_b64_tr_b16 a[60:61], v15 offset:12288
    ds_read_b64_tr_b16 a[62:63], v15 offset:13312
    v_lshlrev_b32 v48, 16, v32
    v_and_b32 v49, 0xffff0000, v32
    v_lshlrev_b32 v50, 16, v33
    v_and_b32 v51, 0xffff0000, v33
    v_mul_f32_dpp v48, v18, v48 row_newbcast:12 row_mask:0xf bank_mask:0xf
    v_mul_f32_dpp v49, v19, v49 row_newbcast:12 row_mask:0xf bank_mask:0xf
    v_mul_f32_dpp v50, v18, v50 row_newbcast:13 row_mask:0xf bank_mask:0xf
    v_mfma_f32_32x32x16_bf16 v[88:103], a[36:39], v[40:43], v[88:103]
    v_mul_f32_dpp v51, v19, v51 row_newbcast:13 row_mask:0xf bank_mask:0xf
    v_cvt_pk_bf16_f32 v44, v48, v49
    v_cvt_pk_bf16_f32 v45, v50, v51
    v_lshlrev_b32 v52, 16, v34
    v_and_b32 v53, 0xffff0000, v34
    v_lshlrev_b32 v54, 16, v35
    v_and_b32 v55, 0xffff0000, v35
    v_mfma_f32_32x32x16_bf16 a[0:15], a[40:43], v[40:43], a[0:15]
    v_mul_f32_dpp v52, v18, v52 row_newbcast:14 row_mask:0xf bank_mask:0xf
    v_mul_f32_dpp v53, v19, v53 row_newbcast:14 row_mask:0xf bank_mask:0xf
    v_mul_f32_dpp v54, v18, v54 row_newbcast:15 row_mask:0xf bank_mask:0xf
    v_mul_f32_dpp v55, v19, v55 row_newbcast:15 row_mask:0xf bank_mask:0xf
    v_cvt_pk_bf16_f32 v46, v52, v53
    v_cvt_pk_bf16_f32 v47, v54, v55
    v_mfma_f32_32x32x16_bf16 a[16:31], a[44:47], v[40:43], a[16:31]
    s_waitcnt lgkmcnt(0)
    s_barrier
    v_mfma_f32_32x32x16_bf16 v[72:87], a[48:51], v[44:47], v[72:87]
    ds_read_b128 v[32:35], v4 offset:4096
    ds_read_b64_tr_b16 a[32:33], v8 offset:0
    ds_read_b64_tr_b16 a[34:35], v8 offset:1024
    ds_read_b64_tr_b16 a[36:37], v9 offset:0
    ds_read_b64_tr_b16 a[38:39], v9 offset:1024
    ds_read_b64_tr_b16 a[40:41], v10 offset:0
    ds_read_b64_tr_b16 a[42:43], v10 offset:1024
    ds_read_b64_tr_b16 a[44:45], v11 offset:0
    ds_read_b64_tr_b16 a[46:47], v11 offset:1024
    v_lshlrev_b32 v48, 16, v36
    v_and_b32 v49, 0xffff0000, v36
    v_lshlrev_b32 v50, 16, v37
    v_and_b32 v51, 0xffff0000, v37
    v_mul_f32_dpp v48, v16, v48 row_newbcast:0 row_mask:0xf bank_mask:0xf
    v_mul_f32_dpp v49, v17, v49 row_newbcast:0 row_mask:0xf bank_mask:0xf
    v_mul_f32_dpp v50, v16, v50 row_newbcast:1 row_mask:0xf bank_mask:0xf
    v_mfma_f32_32x32x16_bf16 v[88:103], a[52:55], v[44:47], v[88:103]
    v_mul_f32_dpp v51, v17, v51 row_newbcast:1 row_mask:0xf bank_mask:0xf
    v_cvt_pk_bf16_f32 v40, v48, v49
    v_cvt_pk_bf16_f32 v41, v50, v51
    v_lshlrev_b32 v52, 16, v38
    v_and_b32 v53, 0xffff0000, v38
    v_lshlrev_b32 v54, 16, v39
    v_and_b32 v55, 0xffff0000, v39
    v_mfma_f32_32x32x16_bf16 a[0:15], a[56:59], v[44:47], a[0:15]
    v_mul_f32_dpp v52, v16, v52 row_newbcast:2 row_mask:0xf bank_mask:0xf
    v_mul_f32_dpp v53, v17, v53 row_newbcast:2 row_mask:0xf bank_mask:0xf
    v_mul_f32_dpp v54, v16, v54 row_newbcast:3 row_mask:0xf bank_mask:0xf
    v_mul_f32_dpp v55, v17, v55 row_newbcast:3 row_mask:0xf bank_mask:0xf
    v_cvt_pk_bf16_f32 v42, v52, v53
    v_cvt_pk_bf16_f32 v43, v54, v55
    v_mfma_f32_32x32x16_bf16 a[16:31], a[60:63], v[44:47], a[16:31]
    v_lshlrev_b32 v18, 16, v63
    v_and_b32 v19, 0xffff0000, v63
    s_waitcnt lgkmcnt(0)
    s_setprio 0
    s_cmp_eq_u32 s41, 0
    s_cbranch_scc0 L_alf25
    s_setprio 1
L_alf25:
    v_mfma_f32_32x32x16_bf16 v[72:87], a[32:35], v[40:43], v[72:87]
    ds_read_b128 v[36:39], v5 offset:4096
    ds_read_b64_tr_b16 a[48:49], v8 offset:4096
    ds_read_b64_tr_b16 a[50:51], v8 offset:5120
    ds_read_b64_tr_b16 a[52:53], v9 offset:4096
    ds_read_b64_tr_b16 a[54:55], v9 offset:5120
    ds_read_b64_tr_b16 a[56:57], v10 offset:4096
    ds_read_b64_tr_b16 a[58:59], v10 offset:5120
    ds_read_b64_tr_b16 a[60:61], v11 offset:4096
    ds_read_b64_tr_b16 a[62:63], v11 offset:5120
    v_lshlrev_b32 v48, 16, v20
    v_and_b32 v49, 0xffff0000, v20
    v_lshlrev_b32 v50, 16, v21
    v_and_b32 v51, 0xffff0000, v21
    v_mul_f32_dpp v48, v16, v48 row_newbcast:4 row_mask:0xf bank_mask:0xf
    v_mul_f32_dpp v49, v17, v49 row_newbcast:4 row_mask:0xf bank_mask:0xf
    v_mul_f32_dpp v50, v16, v50 row_newbcast:5 row_mask:0xf bank_mask:0xf
    v_mfma_f32_32x32x16_bf16 v[88:103], a[36:39], v[40:43], v[88:103]
    v_mul_f32_dpp v51, v17, v51 row_newbcast:5 row_mask:0xf bank_mask:0xf
    v_cvt_pk_bf16_f32 v44, v48, v49
    v_cvt_pk_bf16_f32 v45, v50, v51
    v_lshlrev_b32 v52, 16, v22
    v_and_b32 v53, 0xffff0000, v22
    v_lshlrev_b32 v54, 16, v23
    v_and_b32 v55, 0xffff0000, v23
    v_mfma_f32_32x32x16_bf16 a[0:15], a[40:43], v[40:43], a[0:15]
    v_mul_f32_dpp v52, v16, v52 row_newbcast:6 row_mask:0xf bank_mask:0xf
    v_mul_f32_dpp v53, v17, v53 row_newbcast:6 row_mask:0xf bank_mask:0xf
    v_mul_f32_dpp v54, v16, v54 row_newbcast:7 row_mask:0xf bank_mask:0xf
    v_mul_f32_dpp v55, v17, v55 row_newbcast:7 row_mask:0xf bank_mask:0xf
    v_cvt_pk_bf16_f32 v46, v52, v53
    v_cvt_pk_bf16_f32 v47, v54, v55
    v_mfma_f32_32x32x16_bf16 a[16:31], a[44:47], v[40:43], a[16:31]
    v_and_b32 v48, 31, v1
    v_lshrrev_b32 v49, 5, v1
    s_lshl_b32 s46, s40, 9
    s_add_u32 s46, s46, 98304
    v_lshl_add_u32 v13, v48, 4, s46
    s_lshl_b32 s46, s40, 7
    s_add_u32 s46, s46, 106496
    v_lshl_add_u32 v12, v48, 2, s46
    s_lshl_b32 s47, s41, 9
    v_add_u32 v15, s47, v12
    v_lshl_add_u32 v12, v49, 9, v12
    s_lshl_b32 s46, s41, 8
    s_add_u32 s46, s46, 100352
    v_lshl_add_u32 v14, v48, 2, s46
    v_lshl_add_u32 v14, v49, 9, v14
    s_waitcnt lgkmcnt(0)
    v_mfma_f32_32x32x16_bf16 v[72:87], a[48:51], v[44:47], v[72:87]
    ds_read_b128 v[20:23], v6 offset:4096
    ds_read_b64_tr_b16 a[32:33], v8 offset:8192
    ds_read_b64_tr_b16 a[34:35], v8 offset:9216
    ds_read_b64_tr_b16 a[36:37], v9 offset:8192
    ds_read_b64_tr_b16 a[38:39], v9 offset:9216
    ds_read_b64_tr_b16 a[40:41], v10 offset:8192
    ds_read_b64_tr_b16 a[42:43], v10 offset:9216
    ds_read_b64_tr_b16 a[44:45], v11 offset:8192
    ds_read_b64_tr_b16 a[46:47], v11 offset:9216
    v_lshlrev_b32 v48, 16, v24
    v_and_b32 v49, 0xffff0000, v24
    v_lshlrev_b32 v50, 16, v25
    v_and_b32 v51, 0xffff0000, v25
    v_mul_f32_dpp v48, v16, v48 row_newbcast:8 row_mask:0xf bank_mask:0xf
    v_mul_f32_dpp v49, v17, v49 row_newbcast:8 row_mask:0xf bank_mask:0xf
    v_mul_f32_dpp v50, v16, v50 row_newbcast:9 row_mask:0xf bank_mask:0xf
    v_mfma_f32_32x32x16_bf16 v[88:103], a[52:55], v[44:47], v[88:103]
    v_mul_f32_dpp v51, v17, v51 row_newbcast:9 row_mask:0xf bank_mask:0xf
    v_cvt_pk_bf16_f32 v40, v48, v49
    v_cvt_pk_bf16_f32 v41, v50, v51
    v_lshlrev_b32 v52, 16, v26
    v_and_b32 v53, 0xffff0000, v26
    v_lshlrev_b32 v54, 16, v27
    v_and_b32 v55, 0xffff0000, v27
    v_mfma_f32_32x32x16_bf16 a[0:15], a[56:59], v[44:47], a[0:15]
    v_mul_f32_dpp v52, v16, v52 row_newbcast:10 row_mask:0xf bank_mask:0xf
    v_mul_f32_dpp v53, v17, v53 row_newbcast:10 row_mask:0xf bank_mask:0xf
    v_mul_f32_dpp v54, v16, v54 row_newbcast:11 row_mask:0xf bank_mask:0xf
    v_mul_f32_dpp v55, v17, v55 row_newbcast:11 row_mask:0xf bank_mask:0xf
    v_cvt_pk_bf16_f32 v42, v52, v53
    v_cvt_pk_bf16_f32 v43, v54, v55
    v_mfma_f32_32x32x16_bf16 a[16:31], a[60:63], v[44:47], a[16:31]
    s_waitcnt lgkmcnt(0)
    s_setprio 0
    s_cmp_eq_u32 s41, 1
    s_cbranch_scc0 L_alf27
    s_setprio 1
L_alf27:
    v_mfma_f32_32x32x16_bf16 v[72:87], a[32:35], v[40:43], v[72:87]
    ds_read_b128 v[24:27], v7 offset:4096
    ds_read_b64_tr_b16 a[48:49], v8 offset:12288
    ds_read_b64_tr_b16 a[50:51], v8 offset:13312
    ds_read_b64_tr_b16 a[52:53], v9 offset:12288
    ds_read_b64_tr_b16 a[54:55], v9 offset:13312
    ds_read_b64_tr_b16 a[56:57], v10 offset:12288
    ds_read_b64_tr_b16 a[58:59], v10 offset:13312
    ds_read_b64_tr_b16 a[60:61], v11 offset:12288
    ds_read_b64_tr_b16 a[62:63], v11 offset:13312
    v_lshlrev_b32 v48, 16, v28
    v_and_b32 v49, 0xffff0000, v28
    v_lshlrev_b32 v50, 16, v29
    v_and_b32 v51, 0xffff0000, v29
    v_mul_f32_dpp v48, v16, v48 row_newbcast:12 row_mask:0xf bank_mask:0xf
    v_mul_f32_dpp v49, v17, v49 row_newbcast:12 row_mask:0xf bank_mask:0xf
    v_mul_f32_dpp v50, v16, v50 row_newbcast:13 row_mask:0xf bank_mask:0xf
    v_mfma_f32_32x32x16_bf16 v[88:103], a[36:39], v[40:43], v[88:103]
    v_mul_f32_dpp v51, v17, v51 row_newbcast:13 row_mask:0xf bank_mask:0xf
    v_cvt_pk_bf16_f32 v44, v48, v49
    v_cvt_pk_bf16_f32 v45, v50, v51
    v_lshlrev_b32 v52, 16, v30
    v_and_b32 v53, 0xffff0000, v30
    v_lshlrev_b32 v54, 16, v31
    v_and_b32 v55, 0xffff0000, v31
    v_mfma_f32_32x32x16_bf16 a[0:15], a[40:43], v[40:43], a[0:15]
    v_mul_f32_dpp v52, v16, v52 row_newbcast:14 row_mask:0xf bank_mask:0xf
    v_mul_f32_dpp v53, v17, v53 row_newbcast:14 row_mask:0xf bank_mask:0xf
    v_mul_f32_dpp v54, v16, v54 row_newbcast:15 row_mask:0xf bank_mask:0xf
    v_mul_f32_dpp v55, v17, v55 row_newbcast:15 row_mask:0xf bank_mask:0xf
    v_cvt_pk_bf16_f32 v46, v52, v53
    v_cvt_pk_bf16_f32 v47, v54, v55
    v_mfma_f32_32x32x16_bf16 a[16:31], a[44:47], v[40:43], a[16:31]
    s_waitcnt lgkmcnt(0)
    s_barrier
    v_mfma_f32_32x32x16_bf16 v[72:87], a[48:51], v[44:47], v[72:87]
    ds_read_b64_tr_b16 a[32:33], v8 offset:32768
    ds_read_b64_tr_b16 a[34:35], v8 offset:33792
    ds_read_b64_tr_b16 a[36:37], v9 offset:32768
    ds_read_b64_tr_b16 a[38:39], v9 offset:33792
    ds_read_b64_tr_b16 a[40:41], v10 offset:32768
    ds_read_b64_tr_b16 a[42:43], v10 offset:33792
    ds_read_b64_tr_b16 a[44:45], v11 offset:32768
    ds_read_b64_tr_b16 a[46:47], v11 offset:33792
    v_lshlrev_b32 v48, 16, v32
    v_and_b32 v49, 0xffff0000, v32
    v_lshlrev_b32 v50, 16, v33
    v_and_b32 v51, 0xffff0000, v33
    v_mul_f32_dpp v48, v18, v48 row_newbcast:0 row_mask:0xf bank_mask:0xf
    v_mul_f32_dpp v49, v19, v49 row_newbcast:0 row_mask:0xf bank_mask:0xf
    v_mul_f32_dpp v50, v18, v50 row_newbcast:1 row_mask:0xf bank_mask:0xf
    v_mfma_f32_32x32x16_bf16 v[88:103], a[52:55], v[44:47], v[88:103]
    v_mul_f32_dpp v51, v19, v51 row_newbcast:1 row_mask:0xf bank_mask:0xf
    v_cvt_pk_bf16_f32 v40, v48, v49
    v_cvt_pk_bf16_f32 v41, v50, v51
    v_lshlrev_b32 v52, 16, v34
    v_and_b32 v53, 0xffff0000, v34
    v_lshlrev_b32 v54, 16, v35
    v_and_b32 v55, 0xffff0000, v35
    v_mfma_f32_32x32x16_bf16 a[0:15], a[56:59], v[44:47], a[0:15]
    v_mul_f32_dpp v52, v18, v52 row_newbcast:2 row_mask:0xf bank_mask:0xf
    v_mul_f32_dpp v53, v19, v53 row_newbcast:2 row_mask:0xf bank_mask:0xf
    v_mul_f32_dpp v54, v18, v54 row_newbcast:3 row_mask:0xf bank_mask:0xf
    v_mul_f32_dpp v55, v19, v55 row_newbcast:3 row_mask:0xf bank_mask:0xf
    v_cvt_pk_bf16_f32 v42, v52, v53
    v_cvt_pk_bf16_f32 v43, v54, v55
    v_mfma_f32_32x32x16_bf16 a[16:31], a[60:63], v[44:47], a[16:31]
    s_waitcnt lgkmcnt(0)
    s_setprio 0
    s_cmp_eq_u32 s41, 0
    s_cbranch_scc0 L_alf29
    s_setprio 1
L_alf29:
    v_mfma_f32_32x32x16_bf16 v[72:87], a[32:35], v[40:43], v[72:87]
    ds_read_b64_tr_b16 a[48:49], v8 offset:36864
    ds_read_b64_tr_b16 a[50:51], v8 offset:37888
    ds_read_b64_tr_b16 a[52:53], v9 offset:36864
    ds_read_b64_tr_b16 a[54:55], v9 offset:37888
    ds_read_b64_tr_b16 a[56:57], v10 offset:36864
    ds_read_b64_tr_b16 a[58:59], v10 offset:37888
    ds_read_b64_tr_b16 a[60:61], v11 offset:36864
    ds_read_b64_tr_b16 a[62:63], v11 offset:37888
    v_lshlrev_b32 v48, 16, v36
    v_and_b32 v49, 0xffff0000, v36
    v_lshlrev_b32 v50, 16, v37
    v_and_b32 v51, 0xffff0000, v37
    v_mul_f32_dpp v48, v18, v48 row_newbcast:4 row_mask:0xf bank_mask:0xf
    v_mul_f32_dpp v49, v19, v49 row_newbcast:4 row_mask:0xf bank_mask:0xf
    v_mul_f32_dpp v50, v18, v50 row_newbcast:5 row_mask:0xf bank_mask:0xf
    v_mfma_f32_32x32x16_bf16 v[88:103], a[36:39], v[40:43], v[88:103]
    v_mul_f32_dpp v51, v19, v51 row_newbcast:5 row_mask:0xf bank_mask:0xf
    v_cvt_pk_bf16_f32 v44, v48, v49
    v_cvt_pk_bf16_f32 v45, v50, v51
    v_lshlrev_b32 v52, 16, v38
    v_and_b32 v53, 0xffff0000, v38
    v_lshlrev_b32 v54, 16, v39
    v_and_b32 v55, 0xffff0000, v39
    v_mfma_f32_32x32x16_bf16 a[0:15], a[40:43], v[40:43], a[0:15]
    v_mul_f32_dpp v52, v18, v52 row_newbcast:6 row_mask:0xf bank_mask:0xf
    v_mul_f32_dpp v53, v19, v53 row_newbcast:6 row_mask:0xf bank_mask:0xf
    v_mul_f32_dpp v54, v18, v54 row_newbcast:7 row_mask:0xf bank_mask:0xf
    v_mul_f32_dpp v55, v19, v55 row_newbcast:7 row_mask:0xf bank_mask:0xf
    v_cvt_pk_bf16_f32 v46, v52, v53
    v_cvt_pk_bf16_f32 v47, v54, v55
    v_mfma_f32_32x32x16_bf16 a[16:31], a[44:47], v[40:43], a[16:31]
    ds_write_b32 v15, v2
    s_waitcnt lgkmcnt(0)
    v_mfma_f32_32x32x16_bf16 v[72:87], a[48:51], v[44:47], v[72:87]
    ds_read_b64_tr_b16 a[32:33], v8 offset:40960
    ds_read_b64_tr_b16 a[34:35], v8 offset:41984
    ds_read_b64_tr_b16 a[36:37], v9 offset:40960
    ds_read_b64_tr_b16 a[38:39], v9 offset:41984
    ds_read_b64_tr_b16 a[40:41], v10 offset:40960
    ds_read_b64_tr_b16 a[42:43], v10 offset:41984
    ds_read_b64_tr_b16 a[44:45], v11 offset:40960
    ds_read_b64_tr_b16 a[46:47], v11 offset:41984
    v_lshlrev_b32 v48, 16, v20
    v_and_b32 v49, 0xffff0000, v20
    v_lshlrev_b32 v50, 16, v21
    v_and_b32 v51, 0xffff0000, v21
    v_mul_f32_dpp v48, v18, v48 row_newbcast:8 row_mask:0xf bank_mask:0xf
    v_mul_f32_dpp v49, v19, v49 row_newbcast:8 row_mask:0xf bank_mask:0xf
    v_mul_f32_dpp v50, v18, v50 row_newbcast:9 row_mask:0xf bank_mask:0xf
    v_mfma_f32_32x32x16_bf16 v[88:103], a[52:55], v[44:47], v[88:103]
    v_mul_f32_dpp v51, v19, v51 row_newbcast:9 row_mask:0xf bank_mask:0xf
    v_cvt_pk_bf16_f32 v40, v48, v49
    v_cvt_pk_bf16_f32 v41, v50, v51
    v_lshlrev_b32 v52, 16, v22
    v_and_b32 v53, 0xffff0000, v22
    v_lshlrev_b32 v54, 16, v23
    v_and_b32 v55, 0xffff0000, v23
    v_mfma_f32_32x32x16_bf16 a[0:15], a[56:59], v[44:47], a[0:15]
    v_mul_f32_dpp v52, v18, v52 row_newbcast:10 row_mask:0xf bank_mask:0xf
    v_mul_f32_dpp v53, v19, v53 row_newbcast:10 row_mask:0xf bank_mask:0xf
    v_mul_f32_dpp v54, v18, v54 row_newbcast:11 row_mask:0xf bank_mask:0xf
    v_mul_f32_dpp v55, v19, v55 row_newbcast:11 row_mask:0xf bank_mask:0xf
    v_cvt_pk_bf16_f32 v42, v52, v53
    v_cvt_pk_bf16_f32 v43, v54, v55
    v_mfma_f32_32x32x16_bf16 a[16:31], a[60:63], v[44:47], a[16:31]
    s_waitcnt lgkmcnt(0)
    s_setprio 0
    s_cmp_eq_u32 s41, 1
    s_cbranch_scc0 L_alf31
    s_setprio 1
L_alf31:
    v_mfma_f32_32x32x16_bf16 v[72:87], a[32:35], v[40:43], v[72:87]
    ds_read_b64_tr_b16 a[48:49], v8 offset:45056
    ds_read_b64_tr_b16 a[50:51], v8 offset:46080
    ds_read_b64_tr_b16 a[52:53], v9 offset:45056
    ds_read_b64_tr_b16 a[54:55], v9 offset:46080
    ds_read_b64_tr_b16 a[56:57], v10 offset:45056
    ds_read_b64_tr_b16 a[58:59], v10 offset:46080
    ds_read_b64_tr_b16 a[60:61], v11 offset:45056
    ds_read_b64_tr_b16 a[62:63], v11 offset:46080
    v_lshlrev_b32 v48, 16, v24
    v_and_b32 v49, 0xffff0000, v24
    v_lshlrev_b32 v50, 16, v25
    v_and_b32 v51, 0xffff0000, v25
    v_mul_f32_dpp v48, v18, v48 row_newbcast:12 row_mask:0xf bank_mask:0xf
    v_mul_f32_dpp v49, v19, v49 row_newbcast:12 row_mask:0xf bank_mask:0xf
    v_mul_f32_dpp v50, v18, v50 row_newbcast:13 row_mask:0xf bank_mask:0xf
    v_mfma_f32_32x32x16_bf16 v[88:103], a[36:39], v[40:43], v[88:103]
    v_mul_f32_dpp v51, v19, v51 row_newbcast:13 row_mask:0xf bank_mask:0xf
    v_cvt_pk_bf16_f32 v44, v48, v49
    v_cvt_pk_bf16_f32 v45, v50, v51
    v_lshlrev_b32 v52, 16, v26
    v_and_b32 v53, 0xffff0000, v26
    v_lshlrev_b32 v54, 16, v27
    v_and_b32 v55, 0xffff0000, v27
    v_mfma_f32_32x32x16_bf16 a[0:15], a[40:43], v[40:43], a[0:15]
    v_mul_f32_dpp v52, v18, v52 row_newbcast:14 row_mask:0xf bank_mask:0xf
    v_mul_f32_dpp v53, v19, v53 row_newbcast:14 row_mask:0xf bank_mask:0xf
    v_mul_f32_dpp v54, v18, v54 row_newbcast:15 row_mask:0xf bank_mask:0xf
    v_mul_f32_dpp v55, v19, v55 row_newbcast:15 row_mask:0xf bank_mask:0xf
    v_cvt_pk_bf16_f32 v46, v52, v53
    v_cvt_pk_bf16_f32 v47, v54, v55
    v_mfma_f32_32x32x16_bf16 a[16:31], a[44:47], v[40:43], a[16:31]
    s_waitcnt lgkmcnt(0)
    v_mfma_f32_32x32x16_bf16 a[0:15], a[56:59], v[44:47], a[0:15]
    v_mfma_f32_32x32x16_bf16 a[16:31], a[60:63], v[44:47], a[16:31]
    v_mfma_f32_32x32x16_bf16 v[72:87], a[48:51], v[44:47], v[72:87]
    v_mfma_f32_32x32x16_bf16 v[88:103], a[52:55], v[44:47], v[88:103]
    s_branch L_epi
L_slowloop:
    s_barrier
    ds_read_b128 v[36:39], v4 offset:4096
    ds_read_b64_tr_b16 a[32:33], v8 offset:0
    ds_read_b64_tr_b16 a[34:35], v8 offset:1024
    ds_read_b64_tr_b16 a[36:37], v9 offset:0
    ds_read_b64_tr_b16 a[38:39], v9 offset:1024
    ds_read_b64_tr_b16 a[40:41], v10 offset:0
    ds_read_b64_tr_b16 a[42:43], v10 offset:1024
    ds_read_b64_tr_b16 a[44:45], v11 offset:0
    ds_read_b64_tr_b16 a[46:47], v11 offset:1024
    v_lshlrev_b32 v48, 16, v20
    v_and_b32 v49, 0xffff0000, v20
    v_lshlrev_b32 v50, 16, v21
    v_and_b32 v51, 0xffff0000, v21
    v_sub_f32 v48, v48, v2
    v_sub_f32 v49, v49, v2
    v_sub_f32 v50, v50, v2
    v_sub_f32 v51, v51, v2
    v_mul_f32_dpp v48, v16, v48 row_newbcast:0 row_mask:0xf bank_mask:0xf
    v_mul_f32_dpp v49, v17, v49 row_newbcast:0 row_mask:0xf bank_mask:0xf
    v_mul_f32_dpp v50, v16, v50 row_newbcast:1 row_mask:0xf bank_mask:0xf
    v_mul_f32_dpp v51, v17, v51 row_newbcast:1 row_mask:0xf bank_mask:0xf
    v_cvt_pk_bf16_f32 v40, v48, v49
    v_cvt_pk_bf16_f32 v41, v50, v51
    v_lshlrev_b32 v52, 16, v22
    v_and_b32 v53, 0xffff0000, v22
    v_lshlrev_b32 v54, 16, v23
    v_and_b32 v55, 0xffff0000, v23
    v_sub_f32 v52, v52, v2
    v_sub_f32 v53, v53, v2
    v_sub_f32 v54, v54, v2
    v_sub_f32 v55, v55, v2
    v_mul_f32_dpp v52, v16, v52 row_newbcast:2 row_mask:0xf bank_mask:0xf
    v_mul_f32_dpp v53, v17, v53 row_newbcast:2 row_mask:0xf bank_mask:0xf
    v_mul_f32_dpp v54, v16, v54 row_newbcast:3 row_mask:0xf bank_mask:0xf
    v_mul_f32_dpp v55, v17, v55 row_newbcast:3 row_mask:0xf bank_mask:0xf
    v_cvt_pk_bf16_f32 v42, v52, v53
    v_cvt_pk_bf16_f32 v43, v54, v55
    s_nop 1
    s_waitcnt lgkmcnt(0)
    s_setprio 0
    s_cmp_eq_u32 s41, 0
    s_cbranch_scc0 L_als1
    s_setprio 1
L_als1:
    v_mfma_f32_32x32x16_bf16 v[72:87], a[32:35], v[40:43], v[72:87]
    ds_read_b128 v[20:23], v5 offset:4096
    ds_read_b64_tr_b16 a[48:49], v8 offset:4096
    ds_read_b64_tr_b16 a[50:51], v8 offset:5120
    ds_read_b64_tr_b16 a[52:53], v9 offset:4096
    ds_read_b64_tr_b16 a[54:55], v9 offset:5120
    ds_read_b64_tr_b16 a[56:57], v10 offset:4096
    ds_read_b64_tr_b16 a[58:59], v10 offset:5120
    ds_read_b64_tr_b16 a[60:61], v11 offset:4096
    ds_read_b64_tr_b16 a[62:63], v11 offset:5120
    v_lshlrev_b32 v48, 16, v24
    v_and_b32 v49, 0xffff0000, v24
    v_lshlrev_b32 v50, 16, v25
    v_and_b32 v51, 0xffff0000, v25
    v_sub_f32 v48, v48, v2
    v_sub_f32 v49, v49, v2
    v_sub_f32 v50, v50, v2
    v_sub_f32 v51, v51, v2
    v_mul_f32_dpp v48, v16, v48 row_newbcast:4 row_mask:0xf bank_mask:0xf
    v_mul_f32_dpp v49, v17, v49 row_newbcast:4 row_mask:0xf bank_mask:0xf
    v_mfma_f32_32x32x16_bf16 v[88:103], a[36:39], v[40:43], v[88:103]
    v_mul_f32_dpp v50, v16, v50 row_newbcast:5 row_mask:0xf bank_mask:0xf
    v_mul_f32_dpp v51, v17, v51 row_newbcast:5 row_mask:0xf bank_mask:0xf
    v_cvt_pk_bf16_f32 v44, v48, v49
    v_cvt_pk_bf16_f32 v45, v50, v51
    v_lshlrev_b32 v52, 16, v26
    v_and_b32 v53, 0xffff0000, v26
    v_lshlrev_b32 v54, 16, v27
    v_and_b32 v55, 0xffff0000, v27
    v_sub_f32 v52, v52, v2
    v_sub_f32 v53, v53, v2
    v_mfma_f32_32x32x16_bf16 a[0:15], a[40:43], v[40:43], a[0:15]
    v_sub_f32 v54, v54, v2
    v_sub_f32 v55, v55, v2
    v_mul_f32_dpp v52, v16, v52 row_newbcast:6 row_mask:0xf bank_mask:0xf
    v_mul_f32_dpp v53, v17, v53 row_newbcast:6 row_mask:0xf bank_mask:0xf
    v_mul_f32_dpp v54, v16, v54 row_newbcast:7 row_mask:0xf bank_mask:0xf
    v_mul_f32_dpp v55, v17, v55 row_newbcast:7 row_mask:0xf bank_mask:0xf
    v_cvt_pk_bf16_f32 v46, v52, v53
    v_cvt_pk_bf16_f32 v47, v54, v55
    v_mfma_f32_32x32x16_bf16 a[16:31], a[44:47], v[40:43], a[16:31]
    s_waitcnt lgkmcnt(0)
    v_mfma_f32_32x32x16_bf16 v[72:87], a[48:51], v[44:47], v[72:87]
    ds_read_b128 v[24:27], v6 offset:4096
    ds_read_b64_tr_b16 a[32:33], v8 offset:8192
    ds_read_b64_tr_b16 a[34:35], v8 offset:9216
    ds_read_b64_tr_b16 a[36:37], v9 offset:8192
    ds_read_b64_tr_b16 a[38:39], v9 offset:9216
    ds_read_b64_tr_b16 a[40:41], v10 offset:8192
    ds_read_b64_tr_b16 a[42:43], v10 offset:9216
    ds_read_b64_tr_b16 a[44:45], v11 offset:8192
    ds_read_b64_tr_b16 a[46:47], v11 offset:9216
    v_lshlrev_b32 v48, 16, v28
    v_and_b32 v49, 0xffff0000, v28
    v_lshlrev_b32 v50, 16, v29
    v_and_b32 v51, 0xffff0000, v29
    v_sub_f32 v48, v48, v2
    v_sub_f32 v49, v49, v2
    v_sub_f32 v50, v50, v2
    v_sub_f32 v51, v51, v2
    v_mul_f32_dpp v48, v16, v48 row_newbcast:8 row_mask:0xf bank_mask:0xf
    v_mul_f32_dpp v49, v17, v49 row_newbcast:8 row_mask:0xf bank_mask:0xf
    v_mfma_f32_32x32x16_bf16 v[88:103], a[52:55], v[44:47], v[88:103]
    v_mul_f32_dpp v50, v16, v50 row_newbcast:9 row_mask:0xf bank_mask:0xf
    v_mul_f32_dpp v51, v17, v51 row_newbcast:9 row_mask:0xf bank_mask:0xf
    v_cvt_pk_bf16_f32 v40, v48, v49
    v_cvt_pk_bf16_f32 v41, v50, v51
    v_lshlrev_b32 v52, 16, v30
    v_and_b32 v53, 0xffff0000, v30
    v_lshlrev_b32 v54, 16, v31
    v_and_b32 v55, 0xffff0000, v31
    v_sub_f32 v52, v52, v2
    v_sub_f32 v53, v53, v2
    v_mfma_f32_32x32x16_bf16 a[0:15], a[56:59], v[44:47], a[0:15]
    v_sub_f32 v54, v54, v2
    v_sub_f32 v55, v55, v2
    v_mul_f32_dpp v52, v16, v52 row_newbcast:10 row_mask:0xf bank_mask:0xf
    v_mul_f32_dpp v53, v17, v53 row_newbcast:10 row_mask:0xf bank_mask:0xf
    v_mul_f32_dpp v54, v16, v54 row_newbcast:11 row_mask:0xf bank_mask:0xf
    v_mul_f32_dpp v55, v17, v55 row_newbcast:11 row_mask:0xf bank_mask:0xf
    v_cvt_pk_bf16_f32 v42, v52, v53
    v_cvt_pk_bf16_f32 v43, v54, v55
    v_mfma_f32_32x32x16_bf16 a[16:31], a[60:63], v[44:47], a[16:31]
    s_waitcnt lgkmcnt(0)
    s_setprio 0
    s_cmp_eq_u32 s41, 1
    s_cbranch_scc0 L_als3
    s_setprio 1
L_als3:
    v_mfma_f32_32x32x16_bf16 v[72:87], a[32:35], v[40:43], v[72:87]
    ds_read_b128 v[28:31], v7 offset:4096
    ds_read_b64_tr_b16 a[48:49], v8 offset:12288
    ds_read_b64_tr_b16 a[50:51], v8 offset:13312
    ds_read_b64_tr_b16 a[52:53], v9 offset:12288
    ds_read_b64_tr_b16 a[54:55], v9 offset:13312
    ds_read_b64_tr_b16 a[56:57], v10 offset:12288
    ds_read_b64_tr_b16 a[58:59], v10 offset:13312
    ds_read_b64_tr_b16 a[60:61], v11 offset:12288
    ds_read_b64_tr_b16 a[62:63], v11 offset:13312
    v_lshlrev_b32 v48, 16, v32
    v_and_b32 v49, 0xffff0000, v32
    v_lshlrev_b32 v50, 16, v33
    v_and_b32 v51, 0xffff0000, v33
    v_sub_f32 v48, v48, v2
    v_sub_f32 v49, v49, v2
    v_sub_f32 v50, v50, v2
    v_sub_f32 v51, v51, v2
    v_mul_f32_dpp v48, v16, v48 row_newbcast:12 row_mask:0xf bank_mask:0xf
    v_mul_f32_dpp v49, v17, v49 row_newbcast:12 row_mask:0xf bank_mask:0xf
    v_mfma_f32_32x32x16_bf16 v[88:103], a[36:39], v[40:43], v[88:103]
    v_mul_f32_dpp v50, v16, v50 row_newbcast:13 row_mask:0xf bank_mask:0xf
    v_mul_f32_dpp v51, v17, v51 row_newbcast:13 row_mask:0xf bank_mask:0xf
    v_cvt_pk_bf16_f32 v44, v48, v49
    v_cvt_pk_bf16_f32 v45, v50, v51
    v_lshlrev_b32 v52, 16, v34
    v_and_b32 v53, 0xffff0000, v34
    v_lshlrev_b32 v54, 16, v35
    v_and_b32 v55, 0xffff0000, v35
    v_sub_f32 v52, v52, v2
    v_sub_f32 v53, v53, v2
    v_mfma_f32_32x32x16_bf16 a[0:15], a[40:43], v[40:43], a[0:15]
    v_sub_f32 v54, v54, v2
    v_sub_f32 v55, v55, v2
    v_mul_f32_dpp v52, v16, v52 row_newbcast:14 row_mask:0xf bank_mask:0xf
    v_mul_f32_dpp v53, v17, v53 row_newbcast:14 row_mask:0xf bank_mask:0xf
    v_mul_f32_dpp v54, v16, v54 row_newbcast:15 row_mask:0xf bank_mask:0xf
    v_mul_f32_dpp v55, v17, v55 row_newbcast:15 row_mask:0xf bank_mask:0xf
    v_cvt_pk_bf16_f32 v46, v52, v53
    v_cvt_pk_bf16_f32 v47, v54, v55
    v_mfma_f32_32x32x16_bf16 a[16:31], a[44:47], v[40:43], a[16:31]
    s_waitcnt lgkmcnt(0)
    s_barrier
    v_mfma_f32_32x32x16_bf16 v[72:87], a[48:51], v[44:47], v[72:87]
    ds_read_b128 v[32:35], v4 offset:0
    ds_read_b64_tr_b16 a[32:33], v8 offset:32768
    ds_read_b64_tr_b16 a[34:35], v8 offset:33792
    ds_read_b64_tr_b16 a[36:37], v9 offset:32768
    ds_read_b64_tr_b16 a[38:39], v9 offset:33792
    ds_read_b64_tr_b16 a[40:41], v10 offset:32768
    ds_read_b64_tr_b16 a[42:43], v10 offset:33792
    ds_read_b64_tr_b16 a[44:45], v11 offset:32768
    ds_read_b64_tr_b16 a[46:47], v11 offset:33792
    v_lshlrev_b32 v48, 16, v36
    v_and_b32 v49, 0xffff0000, v36
    v_lshlrev_b32 v50, 16, v37
    v_and_b32 v51, 0xffff0000, v37
    v_sub_f32 v48, v48, v2
    v_sub_f32 v49, v49, v2
    v_sub_f32 v50, v50, v2
    v_sub_f32 v51, v51, v2
    v_mul_f32_dpp v48, v18, v48 row_newbcast:0 row_mask:0xf bank_mask:0xf
    v_mul_f32_dpp v49, v19, v49 row_newbcast:0 row_mask:0xf bank_mask:0xf
    v_mfma_f32_32x32x16_bf16 v[88:103], a[52:55], v[44:47], v[88:103]
    v_mul_f32_dpp v50, v18, v50 row_newbcast:1 row_mask:0xf bank_mask:0xf
    v_mul_f32_dpp v51, v19, v51 row_newbcast:1 row_mask:0xf bank_mask:0xf
    v_cvt_pk_bf16_f32 v40, v48, v49
    v_cvt_pk_bf16_f32 v41, v50, v51
    v_lshlrev_b32 v52, 16, v38
    v_and_b32 v53, 0xffff0000, v38
    v_lshlrev_b32 v54, 16, v39
    v_and_b32 v55, 0xffff0000, v39
    v_sub_f32 v52, v52, v2
    v_sub_f32 v53, v53, v2
    v_mfma_f32_32x32x16_bf16 a[0:15], a[56:59], v[44:47], a[0:15]
    v_sub_f32 v54, v54, v2
    v_sub_f32 v55, v55, v2
    v_mul_f32_dpp v52, v18, v52 row_newbcast:2 row_mask:0xf bank_mask:0xf
    v_mul_f32_dpp v53, v19, v53 row_newbcast:2 row_mask:0xf bank_mask:0xf
    v_mul_f32_dpp v54, v18, v54 row_newbcast:3 row_mask:0xf bank_mask:0xf
    v_mul_f32_dpp v55, v19, v55 row_newbcast:3 row_mask:0xf bank_mask:0xf
    v_cvt_pk_bf16_f32 v42, v52, v53
    v_cvt_pk_bf16_f32 v43, v54, v55
    v_mfma_f32_32x32x16_bf16 a[16:31], a[60:63], v[44:47], a[16:31]
    v_lshlrev_b32 v16, 16, v58
    v_and_b32 v17, 0xffff0000, v58
    s_waitcnt lgkmcnt(0)
    s_setprio 0
    s_cmp_eq_u32 s41, 0
    s_cbranch_scc0 L_als5
    s_setprio 1
L_als5:
    v_mfma_f32_32x32x16_bf16 v[72:87], a[32:35], v[40:43], v[72:87]
    ds_read_b128 v[36:39], v5 offset:0
    ds_read_b64_tr_b16 a[48:49], v8 offset:36864
    ds_read_b64_tr_b16 a[50:51], v8 offset:37888
    ds_read_b64_tr_b16 a[52:53], v9 offset:36864
    ds_read_b64_tr_b16 a[54:55], v9 offset:37888
    ds_read_b64_tr_b16 a[56:57], v10 offset:36864
    ds_read_b64_tr_b16 a[58:59], v10 offset:37888
    ds_read_b64_tr_b16 a[60:61], v11 offset:36864
    ds_read_b64_tr_b16 a[62:63], v11 offset:37888
    v_lshlrev_b32 v48, 16, v20
    v_and_b32 v49, 0xffff0000, v20
    v_lshlrev_b32 v50, 16, v21
    v_and_b32 v51, 0xffff0000, v21
    v_sub_f32 v48, v48, v2
    v_sub_f32 v49, v49, v2
    v_sub_f32 v50, v50, v2
    v_sub_f32 v51, v51, v2
    v_mul_f32_dpp v48, v18, v48 row_newbcast:4 row_mask:0xf bank_mask:0xf
    v_mul_f32_dpp v49, v19, v49 row_newbcast:4 row_mask:0xf bank_mask:0xf
    v_mfma_f32_32x32x16_bf16 v[88:103], a[36:39], v[40:43], v[88:103]
    v_mul_f32_dpp v50, v18, v50 row_newbcast:5 row_mask:0xf bank_mask:0xf
    v_mul_f32_dpp v51, v19, v51 row_newbcast:5 row_mask:0xf bank_mask:0xf
    v_cvt_pk_bf16_f32 v44, v48, v49
    v_cvt_pk_bf16_f32 v45, v50, v51
    v_lshlrev_b32 v52, 16, v22
    v_and_b32 v53, 0xffff0000, v22
    v_lshlrev_b32 v54, 16, v23
    v_and_b32 v55, 0xffff0000, v23
    v_sub_f32 v52, v52, v2
    v_sub_f32 v53, v53, v2
    v_mfma_f32_32x32x16_bf16 a[0:15], a[40:43], v[40:43], a[0:15]
    v_sub_f32 v54, v54, v2
    v_sub_f32 v55, v55, v2
    v_mul_f32_dpp v52, v18, v52 row_newbcast:6 row_mask:0xf bank_mask:0xf
    v_mul_f32_dpp v53, v19, v53 row_newbcast:6 row_mask:0xf bank_mask:0xf
    v_mul_f32_dpp v54, v18, v54 row_newbcast:7 row_mask:0xf bank_mask:0xf
    v_mul_f32_dpp v55, v19, v55 row_newbcast:7 row_mask:0xf bank_mask:0xf
    v_cvt_pk_bf16_f32 v46, v52, v53
    v_cvt_pk_bf16_f32 v47, v54, v55
    v_mfma_f32_32x32x16_bf16 a[16:31], a[44:47], v[40:43], a[16:31]
    s_waitcnt lgkmcnt(0)
    v_mfma_f32_32x32x16_bf16 v[72:87], a[48:51], v[44:47], v[72:87]
    ds_read_b128 v[20:23], v6 offset:0
    ds_read_b64_tr_b16 a[32:33], v8 offset:40960
    ds_read_b64_tr_b16 a[34:35], v8 offset:41984
    ds_read_b64_tr_b16 a[36:37], v9 offset:40960
    ds_read_b64_tr_b16 a[38:39], v9 offset:41984
    ds_read_b64_tr_b16 a[40:41], v10 offset:40960
    ds_read_b64_tr_b16 a[42:43], v10 offset:41984
    ds_read_b64_tr_b16 a[44:45], v11 offset:40960
    ds_read_b64_tr_b16 a[46:47], v11 offset:41984
    v_lshlrev_b32 v48, 16, v24
    v_and_b32 v49, 0xffff0000, v24
    v_lshlrev_b32 v50, 16, v25
    v_and_b32 v51, 0xffff0000, v25
    v_sub_f32 v48, v48, v2
    v_sub_f32 v49, v49, v2
    v_sub_f32 v50, v50, v2
    v_sub_f32 v51, v51, v2
    v_mul_f32_dpp v48, v18, v48 row_newbcast:8 row_mask:0xf bank_mask:0xf
    v_mul_f32_dpp v49, v19, v49 row_newbcast:8 row_mask:0xf bank_mask:0xf
    v_mfma_f32_32x32x16_bf16 v[88:103], a[52:55], v[44:47], v[88:103]
    v_mul_f32_dpp v50, v18, v50 row_newbcast:9 row_mask:0xf bank_mask:0xf
    v_mul_f32_dpp v51, v19, v51 row_newbcast:9 row_mask:0xf bank_mask:0xf
    v_cvt_pk_bf16_f32 v40, v48, v49
    v_cvt_pk_bf16_f32 v41, v50, v51
    v_lshlrev_b32 v52, 16, v26
    v_and_b32 v53, 0xffff0000, v26
    v_lshlrev_b32 v54, 16, v27
    v_and_b32 v55, 0xffff0000, v27
    v_sub_f32 v52, v52, v2
    v_sub_f32 v53, v53, v2
    v_mfma_f32_32x32x16_bf16 a[0:15], a[56:59], v[44:47], a[0:15]
    v_sub_f32 v54, v54, v2
    v_sub_f32 v55, v55, v2
    v_mul_f32_dpp v52, v18, v52 row_newbcast:10 row_mask:0xf bank_mask:0xf
    v_mul_f32_dpp v53, v19, v53 row_newbcast:10 row_mask:0xf bank_mask:0xf
    v_mul_f32_dpp v54, v18, v54 row_newbcast:11 row_mask:0xf bank_mask:0xf
    v_mul_f32_dpp v55, v19, v55 row_newbcast:11 row_mask:0xf bank_mask:0xf
    v_cvt_pk_bf16_f32 v42, v52, v53
    v_cvt_pk_bf16_f32 v43, v54, v55
    v_mfma_f32_32x32x16_bf16 a[16:31], a[60:63], v[44:47], a[16:31]
    s_waitcnt lgkmcnt(0)
    s_setprio 0
    s_cmp_eq_u32 s41, 1
    s_cbranch_scc0 L_als7
    s_setprio 1
L_als7:
    v_mfma_f32_32x32x16_bf16 v[72:87], a[32:35], v[40:43], v[72:87]
    ds_read_b128 v[24:27], v7 offset:0
    ds_read_b64_tr_b16 a[48:49], v8 offset:45056
    ds_read_b64_tr_b16 a[50:51], v8 offset:46080
    ds_read_b64_tr_b16 a[52:53], v9 offset:45056
    ds_read_b64_tr_b16 a[54:55], v9 offset:46080
    ds_read_b64_tr_b16 a[56:57], v10 offset:45056
    ds_read_b64_tr_b16 a[58:59], v10 offset:46080
    ds_read_b64_tr_b16 a[60:61], v11 offset:45056
    ds_read_b64_tr_b16 a[62:63], v11 offset:46080
    v_lshlrev_b32 v48, 16, v28
    v_and_b32 v49, 0xffff0000, v28
    v_lshlrev_b32 v50, 16, v29
    v_and_b32 v51, 0xffff0000, v29
    v_sub_f32 v48, v48, v2
    v_sub_f32 v49, v49, v2
    v_sub_f32 v50, v50, v2
    v_sub_f32 v51, v51, v2
    v_mul_f32_dpp v48, v18, v48 row_newbcast:12 row_mask:0xf bank_mask:0xf
    v_mul_f32_dpp v49, v19, v49 row_newbcast:12 row_mask:0xf bank_mask:0xf
    v_mfma_f32_32x32x16_bf16 v[88:103], a[36:39], v[40:43], v[88:103]
    v_mul_f32_dpp v50, v18, v50 row_newbcast:13 row_mask:0xf bank_mask:0xf
    v_mul_f32_dpp v51, v19, v51 row_newbcast:13 row_mask:0xf bank_mask:0xf
    v_cvt_pk_bf16_f32 v44, v48, v49
    v_cvt_pk_bf16_f32 v45, v50, v51
    v_lshlrev_b32 v52, 16, v30
    v_and_b32 v53, 0xffff0000, v30
    v_lshlrev_b32 v54, 16, v31
    v_and_b32 v55, 0xffff0000, v31
    v_sub_f32 v52, v52, v2
    v_sub_f32 v53, v53, v2
    v_mfma_f32_32x32x16_bf16 a[0:15], a[40:43], v[40:43], a[0:15]
    v_sub_f32 v54, v54, v2
    v_sub_f32 v55, v55, v2
    v_mul_f32_dpp v52, v18, v52 row_newbcast:14 row_mask:0xf bank_mask:0xf
    v_mul_f32_dpp v53, v19, v53 row_newbcast:14 row_mask:0xf bank_mask:0xf
    v_mul_f32_dpp v54, v18, v54 row_newbcast:15 row_mask:0xf bank_mask:0xf
    v_mul_f32_dpp v55, v19, v55 row_newbcast:15 row_mask:0xf bank_mask:0xf
    v_cvt_pk_bf16_f32 v46, v52, v53
    v_cvt_pk_bf16_f32 v47, v54, v55
    v_mfma_f32_32x32x16_bf16 a[16:31], a[44:47], v[40:43], a[16:31]
    s_waitcnt vmcnt(0) lgkmcnt(0)
    s_barrier
    v_mfma_f32_32x32x16_bf16 v[72:87], a[48:51], v[44:47], v[72:87]
    ds_read_b128 v[28:31], v4 offset:4096
    ds_read_b64_tr_b16 a[32:33], v12 offset:0
    ds_read_b64_tr_b16 a[34:35], v12 offset:1024
    ds_read_b64_tr_b16 a[36:37], v13 offset:0
    ds_read_b64_tr_b16 a[38:39], v13 offset:1024
    ds_read_b64_tr_b16 a[40:41], v14 offset:0
    ds_read_b64_tr_b16 a[42:43], v14 offset:1024
    ds_read_b64_tr_b16 a[44:45], v15 offset:0
    ds_read_b64_tr_b16 a[46:47], v15 offset:1024
    v_lshlrev_b32 v48, 16, v32
    v_and_b32 v49, 0xffff0000, v32
    v_lshlrev_b32 v50, 16, v33
    v_and_b32 v51, 0xffff0000, v33
    v_sub_f32 v48, v48, v2
    v_sub_f32 v49, v49, v2
    v_sub_f32 v50, v50, v2
    v_sub_f32 v51, v51, v2
    v_mul_f32_dpp v48, v16, v48 row_newbcast:0 row_mask:0xf bank_mask:0xf
    v_mul_f32_dpp v49, v17, v49 row_newbcast:0 row_mask:0xf bank_mask:0xf
    v_mfma_f32_32x32x16_bf16 v[88:103], a[52:55], v[44:47], v[88:103]
    v_mul_f32_dpp v50, v16, v50 row_newbcast:1 row_mask:0xf bank_mask:0xf
    v_mul_f32_dpp v51, v17, v51 row_newbcast:1 row_mask:0xf bank_mask:0xf
    v_cvt_pk_bf16_f32 v40, v48, v49
    v_cvt_pk_bf16_f32 v41, v50, v51
    v_lshlrev_b32 v52, 16, v34
    v_and_b32 v53, 0xffff0000, v34
    v_lshlrev_b32 v54, 16, v35
    v_and_b32 v55, 0xffff0000, v35
    v_sub_f32 v52, v52, v2
    v_sub_f32 v53, v53, v2
    v_mfma_f32_32x32x16_bf16 a[0:15], a[56:59], v[44:47], a[0:15]
    v_sub_f32 v54, v54, v2
    v_sub_f32 v55, v55, v2
    v_mul_f32_dpp v52, v16, v52 row_newbcast:2 row_mask:0xf bank_mask:0xf
    v_mul_f32_dpp v53, v17, v53 row_newbcast:2 row_mask:0xf bank_mask:0xf
    v_mul_f32_dpp v54, v16, v54 row_newbcast:3 row_mask:0xf bank_mask:0xf
    v_mul_f32_dpp v55, v17, v55 row_newbcast:3 row_mask:0xf bank_mask:0xf
    v_cvt_pk_bf16_f32 v42, v52, v53
    v_cvt_pk_bf16_f32 v43, v54, v55
    v_mfma_f32_32x32x16_bf16 a[16:31], a[60:63], v[44:47], a[16:31]
    v_lshlrev_b32 v18, 16, v59
    v_and_b32 v19, 0xffff0000, v59
    s_waitcnt lgkmcnt(0)
    s_setprio 0
    s_cmp_eq_u32 s41, 0
    s_cbranch_scc0 L_als9
    s_setprio 1
L_als9:
    v_mfma_f32_32x32x16_bf16 v[72:87], a[32:35], v[40:43], v[72:87]
    ds_read_b128 v[32:35], v5 offset:4096
    ds_read_b64_tr_b16 a[48:49], v12 offset:4096
    ds_read_b64_tr_b16 a[50:51], v12 offset:5120
    ds_read_b64_tr_b16 a[52:53], v13 offset:4096
    ds_read_b64_tr_b16 a[54:55], v13 offset:5120
    ds_read_b64_tr_b16 a[56:57], v14 offset:4096
    ds_read_b64_tr_b16 a[58:59], v14 offset:5120
    ds_read_b64_tr_b16 a[60:61], v15 offset:4096
    ds_read_b64_tr_b16 a[62:63], v15 offset:5120
    v_lshlrev_b32 v48, 16, v36
    v_and_b32 v49, 0xffff0000, v36
    v_lshlrev_b32 v50, 16, v37
    v_and_b32 v51, 0xffff0000, v37
    v_sub_f32 v48, v48, v2
    v_sub_f32 v49, v49, v2
    v_sub_f32 v50, v50, v2
    v_sub_f32 v51, v51, v2
    v_mul_f32_dpp v48, v16, v48 row_newbcast:4 row_mask:0xf bank_mask:0xf
    v_mul_f32_dpp v49, v17, v49 row_newbcast:4 row_mask:0xf bank_mask:0xf
    v_mfma_f32_32x32x16_bf16 v[88:103], a[36:39], v[40:43], v[88:103]
    v_mul_f32_dpp v50, v16, v50 row_newbcast:5 row_mask:0xf bank_mask:0xf
    v_mul_f32_dpp v51, v17, v51 row_newbcast:5 row_mask:0xf bank_mask:0xf
    v_cvt_pk_bf16_f32 v44, v48, v49
    v_cvt_pk_bf16_f32 v45, v50, v51
    v_lshlrev_b32 v52, 16, v38
    v_and_b32 v53, 0xffff0000, v38
    v_lshlrev_b32 v54, 16, v39
    v_and_b32 v55, 0xffff0000, v39
    v_sub_f32 v52, v52, v2
    v_sub_f32 v53, v53, v2
    v_mfma_f32_32x32x16_bf16 a[0:15], a[40:43], v[40:43], a[0:15]
    v_sub_f32 v54, v54, v2
    v_sub_f32 v55, v55, v2
    v_mul_f32_dpp v52, v16, v52 row_newbcast:6 row_mask:0xf bank_mask:0xf
    v_mul_f32_dpp v53, v17, v53 row_newbcast:6 row_mask:0xf bank_mask:0xf
    v_mul_f32_dpp v54, v16, v54 row_newbcast:7 row_mask:0xf bank_mask:0xf
    v_mul_f32_dpp v55, v17, v55 row_newbcast:7 row_mask:0xf bank_mask:0xf
    v_cvt_pk_bf16_f32 v46, v52, v53
    v_cvt_pk_bf16_f32 v47, v54, v55
    v_mfma_f32_32x32x16_bf16 a[16:31], a[44:47], v[40:43], a[16:31]
    s_waitcnt lgkmcnt(0)
    v_mfma_f32_32x32x16_bf16 v[72:87], a[48:51], v[44:47], v[72:87]
    ds_read_b128 v[36:39], v6 offset:4096
    ds_read_b64_tr_b16 a[32:33], v12 offset:8192
    ds_read_b64_tr_b16 a[34:35], v12 offset:9216
    ds_read_b64_tr_b16 a[36:37], v13 offset:8192
    ds_read_b64_tr_b16 a[38:39], v13 offset:9216
    ds_read_b64_tr_b16 a[40:41], v14 offset:8192
    ds_read_b64_tr_b16 a[42:43], v14 offset:9216
    ds_read_b64_tr_b16 a[44:45], v15 offset:8192
    ds_read_b64_tr_b16 a[46:47], v15 offset:9216
    v_lshlrev_b32 v48, 16, v20
    v_and_b32 v49, 0xffff0000, v20
    v_lshlrev_b32 v50, 16, v21
    v_and_b32 v51, 0xffff0000, v21
    v_sub_f32 v48, v48, v2
    v_sub_f32 v49, v49, v2
    v_sub_f32 v50, v50, v2
    v_sub_f32 v51, v51, v2
    v_mul_f32_dpp v48, v16, v48 row_newbcast:8 row_mask:0xf bank_mask:0xf
    v_mul_f32_dpp v49, v17, v49 row_newbcast:8 row_mask:0xf bank_mask:0xf
    v_mfma_f32_32x32x16_bf16 v[88:103], a[52:55], v[44:47], v[88:103]
    v_mul_f32_dpp v50, v16, v50 row_newbcast:9 row_mask:0xf bank_mask:0xf
    v_mul_f32_dpp v51, v17, v51 row_newbcast:9 row_mask:0xf bank_mask:0xf
    v_cvt_pk_bf16_f32 v40, v48, v49
    v_cvt_pk_bf16_f32 v41, v50, v51
    v_lshlrev_b32 v52, 16, v22
    v_and_b32 v53, 0xffff0000, v22
    v_lshlrev_b32 v54, 16, v23
    v_and_b32 v55, 0xffff0000, v23
    v_sub_f32 v52, v52, v2
    v_sub_f32 v53, v53, v2
    v_mfma_f32_32x32x16_bf16 a[0:15], a[56:59], v[44:47], a[0:15]
    v_sub_f32 v54, v54, v2
    v_sub_f32 v55, v55, v2
    v_mul_f32_dpp v52, v16, v52 row_newbcast:10 row_mask:0xf bank_mask:0xf
    v_mul_f32_dpp v53, v17, v53 row_newbcast:10 row_mask:0xf bank_mask:0xf
    v_mul_f32_dpp v54, v16, v54 row_newbcast:11 row_mask:0xf bank_mask:0xf
    v_mul_f32_dpp v55, v17, v55 row_newbcast:11 row_mask:0xf bank_mask:0xf
    v_cvt_pk_bf16_f32 v42, v52, v53
    v_cvt_pk_bf16_f32 v43, v54, v55
    v_mfma_f32_32x32x16_bf16 a[16:31], a[60:63], v[44:47], a[16:31]
    s_waitcnt lgkmcnt(0)
    s_setprio 0
    s_cmp_eq_u32 s41, 1
    s_cbranch_scc0 L_als11
    s_setprio 1
L_als11:
    v_mfma_f32_32x32x16_bf16 v[72:87], a[32:35], v[40:43], v[72:87]
    ds_read_b128 v[20:23], v7 offset:4096
    ds_read_b64_tr_b16 a[48:49], v12 offset:12288
    ds_read_b64_tr_b16 a[50:51], v12 offset:13312
    ds_read_b64_tr_b16 a[52:53], v13 offset:12288
    ds_read_b64_tr_b16 a[54:55], v13 offset:13312
    ds_read_b64_tr_b16 a[56:57], v14 offset:12288
    ds_read_b64_tr_b16 a[58:59], v14 offset:13312
    ds_read_b64_tr_b16 a[60:61], v15 offset:12288
    ds_read_b64_tr_b16 a[62:63], v15 offset:13312
    v_lshlrev_b32 v48, 16, v24
    v_and_b32 v49, 0xffff0000, v24
    v_lshlrev_b32 v50, 16, v25
    v_and_b32 v51, 0xffff0000, v25
    v_sub_f32 v48, v48, v2
    v_sub_f32 v49, v49, v2
    v_sub_f32 v50, v50, v2
    v_sub_f32 v51, v51, v2
    v_mul_f32_dpp v48, v16, v48 row_newbcast:12 row_mask:0xf bank_mask:0xf
    v_mul_f32_dpp v49, v17, v49 row_newbcast:12 row_mask:0xf bank_mask:0xf
    v_mfma_f32_32x32x16_bf16 v[88:103], a[36:39], v[40:43], v[88:103]
    v_mul_f32_dpp v50, v16, v50 row_newbcast:13 row_mask:0xf bank_mask:0xf
    v_mul_f32_dpp v51, v17, v51 row_newbcast:13 row_mask:0xf bank_mask:0xf
    v_cvt_pk_bf16_f32 v44, v48, v49
    v_cvt_pk_bf16_f32 v45, v50, v51
    v_lshlrev_b32 v52, 16, v26
    v_and_b32 v53, 0xffff0000, v26
    v_lshlrev_b32 v54, 16, v27
    v_and_b32 v55, 0xffff0000, v27
    v_sub_f32 v52, v52, v2
    v_sub_f32 v53, v53, v2
    v_mfma_f32_32x32x16_bf16 a[0:15], a[40:43], v[40:43], a[0:15]
    v_sub_f32 v54, v54, v2
    v_sub_f32 v55, v55, v2
    v_mul_f32_dpp v52, v16, v52 row_newbcast:14 row_mask:0xf bank_mask:0xf
    v_mul_f32_dpp v53, v17, v53 row_newbcast:14 row_mask:0xf bank_mask:0xf
    v_mul_f32_dpp v54, v16, v54 row_newbcast:15 row_mask:0xf bank_mask:0xf
    v_mul_f32_dpp v55, v17, v55 row_newbcast:15 row_mask:0xf bank_mask:0xf
    v_cvt_pk_bf16_f32 v46, v52, v53
    v_cvt_pk_bf16_f32 v47, v54, v55
    v_mfma_f32_32x32x16_bf16 a[16:31], a[44:47], v[40:43], a[16:31]
    s_waitcnt lgkmcnt(0)
    s_barrier
    v_mfma_f32_32x32x16_bf16 v[72:87], a[48:51], v[44:47], v[72:87]
    ds_read_b128 v[24:27], v4 offset:0
    ds_read_b64_tr_b16 a[32:33], v8 offset:0
    ds_read_b64_tr_b16 a[34:35], v8 offset:1024
    ds_read_b64_tr_b16 a[36:37], v9 offset:0
    ds_read_b64_tr_b16 a[38:39], v9 offset:1024
    ds_read_b64_tr_b16 a[40:41], v10 offset:0
    ds_read_b64_tr_b16 a[42:43], v10 offset:1024
    ds_read_b64_tr_b16 a[44:45], v11 offset:0
    ds_read_b64_tr_b16 a[46:47], v11 offset:1024
    v_lshlrev_b32 v48, 16, v28
    v_and_b32 v49, 0xffff0000, v28
    v_lshlrev_b32 v50, 16, v29
    v_and_b32 v51, 0xffff0000, v29
    v_sub_f32 v48, v48, v2
    v_sub_f32 v49, v49, v2
    v_sub_f32 v50, v50, v2
    v_sub_f32 v51, v51, v2
    v_mul_f32_dpp v48, v18, v48 row_newbcast:0 row_mask:0xf bank_mask:0xf
    v_mul_f32_dpp v49, v19, v49 row_newbcast:0 row_mask:0xf bank_mask:0xf
    v_mfma_f32_32x32x16_bf16 v[88:103], a[52:55], v[44:47], v[88:103]
    v_mul_f32_dpp v50, v18, v50 row_newbcast:1 row_mask:0xf bank_mask:0xf
    v_mul_f32_dpp v51, v19, v51 row_newbcast:1 row_mask:0xf bank_mask:0xf
    v_cvt_pk_bf16_f32 v40, v48, v49
    v_cvt_pk_bf16_f32 v41, v50, v51
    v_lshlrev_b32 v52, 16, v30
    v_and_b32 v53, 0xffff0000, v30
    v_lshlrev_b32 v54, 16, v31
    v_and_b32 v55, 0xffff0000, v31
    v_sub_f32 v52, v52, v2
    v_sub_f32 v53, v53, v2
    v_mfma_f32_32x32x16_bf16 a[0:15], a[56:59], v[44:47], a[0:15]
    v_sub_f32 v54, v54, v2
    v_sub_f32 v55, v55, v2
    v_mul_f32_dpp v52, v18, v52 row_newbcast:2 row_mask:0xf bank_mask:0xf
    v_mul_f32_dpp v53, v19, v53 row_newbcast:2 row_mask:0xf bank_mask:0xf
    v_mul_f32_dpp v54, v18, v54 row_newbcast:3 row_mask:0xf bank_mask:0xf
    v_mul_f32_dpp v55, v19, v55 row_newbcast:3 row_mask:0xf bank_mask:0xf
    v_cvt_pk_bf16_f32 v42, v52, v53
    v_cvt_pk_bf16_f32 v43, v54, v55
    v_mfma_f32_32x32x16_bf16 a[16:31], a[60:63], v[44:47], a[16:31]
    v_lshlrev_b32 v16, 16, v60
    v_and_b32 v17, 0xffff0000, v60
    s_waitcnt lgkmcnt(0)
    s_setprio 0
    s_cmp_eq_u32 s41, 0
    s_cbranch_scc0 L_als13
    s_setprio 1
L_als13:
    v_mfma_f32_32x32x16_bf16 v[72:87], a[32:35], v[40:43], v[72:87]
    ds_read_b128 v[28:31], v5 offset:0
    ds_read_b64_tr_b16 a[48:49], v8 offset:4096
    ds_read_b64_tr_b16 a[50:51], v8 offset:5120
    ds_read_b64_tr_b16 a[52:53], v9 offset:4096
    ds_read_b64_tr_b16 a[54:55], v9 offset:5120
    ds_read_b64_tr_b16 a[56:57], v10 offset:4096
    ds_read_b64_tr_b16 a[58:59], v10 offset:5120
    ds_read_b64_tr_b16 a[60:61], v11 offset:4096
    ds_read_b64_tr_b16 a[62:63], v11 offset:5120
    v_lshlrev_b32 v48, 16, v32
    v_and_b32 v49, 0xffff0000, v32
    v_lshlrev_b32 v50, 16, v33
    v_and_b32 v51, 0xffff0000, v33
    v_sub_f32 v48, v48, v2
    v_sub_f32 v49, v49, v2
    v_sub_f32 v50, v50, v2
    v_sub_f32 v51, v51, v2
    v_mul_f32_dpp v48, v18, v48 row_newbcast:4 row_mask:0xf bank_mask:0xf
    v_mul_f32_dpp v49, v19, v49 row_newbcast:4 row_mask:0xf bank_mask:0xf
    v_mfma_f32_32x32x16_bf16 v[88:103], a[36:39], v[40:43], v[88:103]
    v_mul_f32_dpp v50, v18, v50 row_newbcast:5 row_mask:0xf bank_mask:0xf
    v_mul_f32_dpp v51, v19, v51 row_newbcast:5 row_mask:0xf bank_mask:0xf
    v_cvt_pk_bf16_f32 v44, v48, v49
    v_cvt_pk_bf16_f32 v45, v50, v51
    v_lshlrev_b32 v52, 16, v34
    v_and_b32 v53, 0xffff0000, v34
    v_lshlrev_b32 v54, 16, v35
    v_and_b32 v55, 0xffff0000, v35
    v_sub_f32 v52, v52, v2
    v_sub_f32 v53, v53, v2
    v_mfma_f32_32x32x16_bf16 a[0:15], a[40:43], v[40:43], a[0:15]
    v_sub_f32 v54, v54, v2
    v_sub_f32 v55, v55, v2
    v_mul_f32_dpp v52, v18, v52 row_newbcast:6 row_mask:0xf bank_mask:0xf
    v_mul_f32_dpp v53, v19, v53 row_newbcast:6 row_mask:0xf bank_mask:0xf
    v_mul_f32_dpp v54, v18, v54 row_newbcast:7 row_mask:0xf bank_mask:0xf
    v_mul_f32_dpp v55, v19, v55 row_newbcast:7 row_mask:0xf bank_mask:0xf
    v_cvt_pk_bf16_f32 v46, v52, v53
    v_cvt_pk_bf16_f32 v47, v54, v55
    v_mfma_f32_32x32x16_bf16 a[16:31], a[44:47], v[40:43], a[16:31]
    s_waitcnt lgkmcnt(0)
    v_mfma_f32_32x32x16_bf16 v[72:87], a[48:51], v[44:47], v[72:87]
    ds_read_b128 v[32:35], v6 offset:0
    ds_read_b64_tr_b16 a[32:33], v8 offset:8192
    ds_read_b64_tr_b16 a[34:35], v8 offset:9216
    ds_read_b64_tr_b16 a[36:37], v9 offset:8192
    ds_read_b64_tr_b16 a[38:39], v9 offset:9216
    ds_read_b64_tr_b16 a[40:41], v10 offset:8192
    ds_read_b64_tr_b16 a[42:43], v10 offset:9216
    ds_read_b64_tr_b16 a[44:45], v11 offset:8192
    ds_read_b64_tr_b16 a[46:47], v11 offset:9216
    v_lshlrev_b32 v48, 16, v36
    v_and_b32 v49, 0xffff0000, v36
    v_lshlrev_b32 v50, 16, v37
    v_and_b32 v51, 0xffff0000, v37
    v_sub_f32 v48, v48, v2
    v_sub_f32 v49, v49, v2
    v_sub_f32 v50, v50, v2
    v_sub_f32 v51, v51, v2
    v_mul_f32_dpp v48, v18, v48 row_newbcast:8 row_mask:0xf bank_mask:0xf
    v_mul_f32_dpp v49, v19, v49 row_newbcast:8 row_mask:0xf bank_mask:0xf
    v_mfma_f32_32x32x16_bf16 v[88:103], a[52:55], v[44:47], v[88:103]
    v_mul_f32_dpp v50, v18, v50 row_newbcast:9 row_mask:0xf bank_mask:0xf
    v_mul_f32_dpp v51, v19, v51 row_newbcast:9 row_mask:0xf bank_mask:0xf
    v_cvt_pk_bf16_f32 v40, v48, v49
    v_cvt_pk_bf16_f32 v41, v50, v51
    v_lshlrev_b32 v52, 16, v38
    v_and_b32 v53, 0xffff0000, v38
    v_lshlrev_b32 v54, 16, v39
    v_and_b32 v55, 0xffff0000, v39
    v_sub_f32 v52, v52, v2
    v_sub_f32 v53, v53, v2
    v_mfma_f32_32x32x16_bf16 a[0:15], a[56:59], v[44:47], a[0:15]
    v_sub_f32 v54, v54, v2
    v_sub_f32 v55, v55, v2
    v_mul_f32_dpp v52, v18, v52 row_newbcast:10 row_mask:0xf bank_mask:0xf
    v_mul_f32_dpp v53, v19, v53 row_newbcast:10 row_mask:0xf bank_mask:0xf
    v_mul_f32_dpp v54, v18, v54 row_newbcast:11 row_mask:0xf bank_mask:0xf
    v_mul_f32_dpp v55, v19, v55 row_newbcast:11 row_mask:0xf bank_mask:0xf
    v_cvt_pk_bf16_f32 v42, v52, v53
    v_cvt_pk_bf16_f32 v43, v54, v55
    v_mfma_f32_32x32x16_bf16 a[16:31], a[60:63], v[44:47], a[16:31]
    s_waitcnt lgkmcnt(0)
    s_setprio 0
    s_cmp_eq_u32 s41, 1
    s_cbranch_scc0 L_als15
    s_setprio 1
L_als15:
    v_mfma_f32_32x32x16_bf16 v[72:87], a[32:35], v[40:43], v[72:87]
    ds_read_b128 v[36:39], v7 offset:0
    ds_read_b64_tr_b16 a[48:49], v8 offset:12288
    ds_read_b64_tr_b16 a[50:51], v8 offset:13312
    ds_read_b64_tr_b16 a[52:53], v9 offset:12288
    ds_read_b64_tr_b16 a[54:55], v9 offset:13312
    ds_read_b64_tr_b16 a[56:57], v10 offset:12288
    ds_read_b64_tr_b16 a[58:59], v10 offset:13312
    ds_read_b64_tr_b16 a[60:61], v11 offset:12288
    ds_read_b64_tr_b16 a[62:63], v11 offset:13312
    v_lshlrev_b32 v48, 16, v20
    v_and_b32 v49, 0xffff0000, v20
    v_lshlrev_b32 v50, 16, v21
    v_and_b32 v51, 0xffff0000, v21
    v_sub_f32 v48, v48, v2
    v_sub_f32 v49, v49, v2
    v_sub_f32 v50, v50, v2
    v_sub_f32 v51, v51, v2
    v_mul_f32_dpp v48, v18, v48 row_newbcast:12 row_mask:0xf bank_mask:0xf
    v_mul_f32_dpp v49, v19, v49 row_newbcast:12 row_mask:0xf bank_mask:0xf
    v_mfma_f32_32x32x16_bf16 v[88:103], a[36:39], v[40:43], v[88:103]
    v_mul_f32_dpp v50, v18, v50 row_newbcast:13 row_mask:0xf bank_mask:0xf
    v_mul_f32_dpp v51, v19, v51 row_newbcast:13 row_mask:0xf bank_mask:0xf
    v_cvt_pk_bf16_f32 v44, v48, v49
    v_cvt_pk_bf16_f32 v45, v50, v51
    v_lshlrev_b32 v52, 16, v22
    v_and_b32 v53, 0xffff0000, v22
    v_lshlrev_b32 v54, 16, v23
    v_and_b32 v55, 0xffff0000, v23
    v_sub_f32 v52, v52, v2
    v_sub_f32 v53, v53, v2
    v_mfma_f32_32x32x16_bf16 a[0:15], a[40:43], v[40:43], a[0:15]
    v_sub_f32 v54, v54, v2
    v_sub_f32 v55, v55, v2
    v_mul_f32_dpp v52, v18, v52 row_newbcast:14 row_mask:0xf bank_mask:0xf
    v_mul_f32_dpp v53, v19, v53 row_newbcast:14 row_mask:0xf bank_mask:0xf
    v_mul_f32_dpp v54, v18, v54 row_newbcast:15 row_mask:0xf bank_mask:0xf
    v_mul_f32_dpp v55, v19, v55 row_newbcast:15 row_mask:0xf bank_mask:0xf
    v_cvt_pk_bf16_f32 v46, v52, v53
    v_cvt_pk_bf16_f32 v47, v54, v55
    v_mfma_f32_32x32x16_bf16 a[16:31], a[44:47], v[40:43], a[16:31]
    s_waitcnt lgkmcnt(0)
    s_barrier
    v_mfma_f32_32x32x16_bf16 v[72:87], a[48:51], v[44:47], v[72:87]
    ds_read_b128 v[20:23], v4 offset:4096
    ds_read_b64_tr_b16 a[32:33], v8 offset:32768
    ds_read_b64_tr_b16 a[34:35], v8 offset:33792
    ds_read_b64_tr_b16 a[36:37], v9 offset:32768
    ds_read_b64_tr_b16 a[38:39], v9 offset:33792
    ds_read_b64_tr_b16 a[40:41], v10 offset:32768
    ds_read_b64_tr_b16 a[42:43], v10 offset:33792
    ds_read_b64_tr_b16 a[44:45], v11 offset:32768
    ds_read_b64_tr_b16 a[46:47], v11 offset:33792
    v_lshlrev_b32 v48, 16, v24
    v_and_b32 v49, 0xffff0000, v24
    v_lshlrev_b32 v50, 16, v25
    v_and_b32 v51, 0xffff0000, v25
    v_sub_f32 v48, v48, v2
    v_sub_f32 v49, v49, v2
    v_sub_f32 v50, v50, v2
    v_sub_f32 v51, v51, v2
    v_mul_f32_dpp v48, v16, v48 row_newbcast:0 row_mask:0xf bank_mask:0xf
    v_mul_f32_dpp v49, v17, v49 row_newbcast:0 row_mask:0xf bank_mask:0xf
    v_mfma_f32_32x32x16_bf16 v[88:103], a[52:55], v[44:47], v[88:103]
    v_mul_f32_dpp v50, v16, v50 row_newbcast:1 row_mask:0xf bank_mask:0xf
    v_mul_f32_dpp v51, v17, v51 row_newbcast:1 row_mask:0xf bank_mask:0xf
    v_cvt_pk_bf16_f32 v40, v48, v49
    v_cvt_pk_bf16_f32 v41, v50, v51
    v_lshlrev_b32 v52, 16, v26
    v_and_b32 v53, 0xffff0000, v26
    v_lshlrev_b32 v54, 16, v27
    v_and_b32 v55, 0xffff0000, v27
    v_sub_f32 v52, v52, v2
    v_sub_f32 v53, v53, v2
    v_mfma_f32_32x32x16_bf16 a[0:15], a[56:59], v[44:47], a[0:15]
    v_sub_f32 v54, v54, v2
    v_sub_f32 v55, v55, v2
    v_mul_f32_dpp v52, v16, v52 row_newbcast:2 row_mask:0xf bank_mask:0xf
    v_mul_f32_dpp v53, v17, v53 row_newbcast:2 row_mask:0xf bank_mask:0xf
    v_mul_f32_dpp v54, v16, v54 row_newbcast:3 row_mask:0xf bank_mask:0xf
    v_mul_f32_dpp v55, v17, v55 row_newbcast:3 row_mask:0xf bank_mask:0xf
    v_cvt_pk_bf16_f32 v42, v52, v53
    v_cvt_pk_bf16_f32 v43, v54, v55
    v_mfma_f32_32x32x16_bf16 a[16:31], a[60:63], v[44:47], a[16:31]
    v_lshlrev_b32 v18, 16, v61
    v_and_b32 v19, 0xffff0000, v61
    s_waitcnt lgkmcnt(0)
    s_setprio 0
    s_cmp_eq_u32 s41, 0
    s_cbranch_scc0 L_als17
    s_setprio 1
L_als17:
    v_mfma_f32_32x32x16_bf16 v[72:87], a[32:35], v[40:43], v[72:87]
    ds_read_b128 v[24:27], v5 offset:4096
    ds_read_b64_tr_b16 a[48:49], v8 offset:36864
    ds_read_b64_tr_b16 a[50:51], v8 offset:37888
    ds_read_b64_tr_b16 a[52:53], v9 offset:36864
    ds_read_b64_tr_b16 a[54:55], v9 offset:37888
    ds_read_b64_tr_b16 a[56:57], v10 offset:36864
    ds_read_b64_tr_b16 a[58:59], v10 offset:37888
    ds_read_b64_tr_b16 a[60:61], v11 offset:36864
    ds_read_b64_tr_b16 a[62:63], v11 offset:37888
    v_lshlrev_b32 v48, 16, v28
    v_and_b32 v49, 0xffff0000, v28
    v_lshlrev_b32 v50, 16, v29
    v_and_b32 v51, 0xffff0000, v29
    v_sub_f32 v48, v48, v2
    v_sub_f32 v49, v49, v2
    v_sub_f32 v50, v50, v2
    v_sub_f32 v51, v51, v2
    v_mul_f32_dpp v48, v16, v48 row_newbcast:4 row_mask:0xf bank_mask:0xf
    v_mul_f32_dpp v49, v17, v49 row_newbcast:4 row_mask:0xf bank_mask:0xf
    v_mfma_f32_32x32x16_bf16 v[88:103], a[36:39], v[40:43], v[88:103]
    v_mul_f32_dpp v50, v16, v50 row_newbcast:5 row_mask:0xf bank_mask:0xf
    v_mul_f32_dpp v51, v17, v51 row_newbcast:5 row_mask:0xf bank_mask:0xf
    v_cvt_pk_bf16_f32 v44, v48, v49
    v_cvt_pk_bf16_f32 v45, v50, v51
    v_lshlrev_b32 v52, 16, v30
    v_and_b32 v53, 0xffff0000, v30
    v_lshlrev_b32 v54, 16, v31
    v_and_b32 v55, 0xffff0000, v31
    v_sub_f32 v52, v52, v2
    v_sub_f32 v53, v53, v2
    v_mfma_f32_32x32x16_bf16 a[0:15], a[40:43], v[40:43], a[0:15]
    v_sub_f32 v54, v54, v2
    v_sub_f32 v55, v55, v2
    v_mul_f32_dpp v52, v16, v52 row_newbcast:6 row_mask:0xf bank_mask:0xf
    v_mul_f32_dpp v53, v17, v53 row_newbcast:6 row_mask:0xf bank_mask:0xf
    v_mul_f32_dpp v54, v16, v54 row_newbcast:7 row_mask:0xf bank_mask:0xf
    v_mul_f32_dpp v55, v17, v55 row_newbcast:7 row_mask:0xf bank_mask:0xf
    v_cvt_pk_bf16_f32 v46, v52, v53
    v_cvt_pk_bf16_f32 v47, v54, v55
    v_mfma_f32_32x32x16_bf16 a[16:31], a[44:47], v[40:43], a[16:31]
    s_waitcnt lgkmcnt(0)
    v_mfma_f32_32x32x16_bf16 v[72:87], a[48:51], v[44:47], v[72:87]
    ds_read_b128 v[28:31], v6 offset:4096
    ds_read_b64_tr_b16 a[32:33], v8 offset:40960
    ds_read_b64_tr_b16 a[34:35], v8 offset:41984
    ds_read_b64_tr_b16 a[36:37], v9 offset:40960
    ds_read_b64_tr_b16 a[38:39], v9 offset:41984
    ds_read_b64_tr_b16 a[40:41], v10 offset:40960
    ds_read_b64_tr_b16 a[42:43], v10 offset:41984
    ds_read_b64_tr_b16 a[44:45], v11 offset:40960
    ds_read_b64_tr_b16 a[46:47], v11 offset:41984
    v_lshlrev_b32 v48, 16, v32
    v_and_b32 v49, 0xffff0000, v32
    v_lshlrev_b32 v50, 16, v33
    v_and_b32 v51, 0xffff0000, v33
    v_sub_f32 v48, v48, v2
    v_sub_f32 v49, v49, v2
    v_sub_f32 v50, v50, v2
    v_sub_f32 v51, v51, v2
    v_mul_f32_dpp v48, v16, v48 row_newbcast:8 row_mask:0xf bank_mask:0xf
    v_mul_f32_dpp v49, v17, v49 row_newbcast:8 row_mask:0xf bank_mask:0xf
    v_mfma_f32_32x32x16_bf16 v[88:103], a[52:55], v[44:47], v[88:103]
    v_mul_f32_dpp v50, v16, v50 row_newbcast:9 row_mask:0xf bank_mask:0xf
    v_mul_f32_dpp v51, v17, v51 row_newbcast:9 row_mask:0xf bank_mask:0xf
    v_cvt_pk_bf16_f32 v40, v48, v49
    v_cvt_pk_bf16_f32 v41, v50, v51
    v_lshlrev_b32 v52, 16, v34
    v_and_b32 v53, 0xffff0000, v34
    v_lshlrev_b32 v54, 16, v35
    v_and_b32 v55, 0xffff0000, v35
    v_sub_f32 v52, v52, v2
    v_sub_f32 v53, v53, v2
    v_mfma_f32_32x32x16_bf16 a[0:15], a[56:59], v[44:47], a[0:15]
    v_sub_f32 v54, v54, v2
    v_sub_f32 v55, v55, v2
    v_mul_f32_dpp v52, v16, v52 row_newbcast:10 row_mask:0xf bank_mask:0xf
    v_mul_f32_dpp v53, v17, v53 row_newbcast:10 row_mask:0xf bank_mask:0xf
    v_mul_f32_dpp v54, v16, v54 row_newbcast:11 row_mask:0xf bank_mask:0xf
    v_mul_f32_dpp v55, v17, v55 row_newbcast:11 row_mask:0xf bank_mask:0xf
    v_cvt_pk_bf16_f32 v42, v52, v53
    v_cvt_pk_bf16_f32 v43, v54, v55
    v_mfma_f32_32x32x16_bf16 a[16:31], a[60:63], v[44:47], a[16:31]
    s_waitcnt lgkmcnt(0)
    s_setprio 0
    s_cmp_eq_u32 s41, 1
    s_cbranch_scc0 L_als19
    s_setprio 1
L_als19:
    v_mfma_f32_32x32x16_bf16 v[72:87], a[32:35], v[40:43], v[72:87]
    ds_read_b128 v[32:35], v7 offset:4096
    ds_read_b64_tr_b16 a[48:49], v8 offset:45056
    ds_read_b64_tr_b16 a[50:51], v8 offset:46080
    ds_read_b64_tr_b16 a[52:53], v9 offset:45056
    ds_read_b64_tr_b16 a[54:55], v9 offset:46080
    ds_read_b64_tr_b16 a[56:57], v10 offset:45056
    ds_read_b64_tr_b16 a[58:59], v10 offset:46080
    ds_read_b64_tr_b16 a[60:61], v11 offset:45056
    ds_read_b64_tr_b16 a[62:63], v11 offset:46080
    v_lshlrev_b32 v48, 16, v36
    v_and_b32 v49, 0xffff0000, v36
    v_lshlrev_b32 v50, 16, v37
    v_and_b32 v51, 0xffff0000, v37
    v_sub_f32 v48, v48, v2
    v_sub_f32 v49, v49, v2
    v_sub_f32 v50, v50, v2
    v_sub_f32 v51, v51, v2
    v_mul_f32_dpp v48, v16, v48 row_newbcast:12 row_mask:0xf bank_mask:0xf
    v_mul_f32_dpp v49, v17, v49 row_newbcast:12 row_mask:0xf bank_mask:0xf
    v_mfma_f32_32x32x16_bf16 v[88:103], a[36:39], v[40:43], v[88:103]
    v_mul_f32_dpp v50, v16, v50 row_newbcast:13 row_mask:0xf bank_mask:0xf
    v_mul_f32_dpp v51, v17, v51 row_newbcast:13 row_mask:0xf bank_mask:0xf
    v_cvt_pk_bf16_f32 v44, v48, v49
    v_cvt_pk_bf16_f32 v45, v50, v51
    v_lshlrev_b32 v52, 16, v38
    v_and_b32 v53, 0xffff0000, v38
    v_lshlrev_b32 v54, 16, v39
    v_and_b32 v55, 0xffff0000, v39
    v_sub_f32 v52, v52, v2
    v_sub_f32 v53, v53, v2
    v_mfma_f32_32x32x16_bf16 a[0:15], a[40:43], v[40:43], a[0:15]
    v_sub_f32 v54, v54, v2
    v_sub_f32 v55, v55, v2
    v_mul_f32_dpp v52, v16, v52 row_newbcast:14 row_mask:0xf bank_mask:0xf
    v_mul_f32_dpp v53, v17, v53 row_newbcast:14 row_mask:0xf bank_mask:0xf
    v_mul_f32_dpp v54, v16, v54 row_newbcast:15 row_mask:0xf bank_mask:0xf
    v_mul_f32_dpp v55, v17, v55 row_newbcast:15 row_mask:0xf bank_mask:0xf
    v_cvt_pk_bf16_f32 v46, v52, v53
    v_cvt_pk_bf16_f32 v47, v54, v55
    v_mfma_f32_32x32x16_bf16 a[16:31], a[44:47], v[40:43], a[16:31]
    s_waitcnt lgkmcnt(0)
    s_barrier
    v_mfma_f32_32x32x16_bf16 v[72:87], a[48:51], v[44:47], v[72:87]
    ds_read_b128 v[36:39], v4 offset:0
    ds_read_b64_tr_b16 a[32:33], v12 offset:0
    ds_read_b64_tr_b16 a[34:35], v12 offset:1024
    ds_read_b64_tr_b16 a[36:37], v13 offset:0
    ds_read_b64_tr_b16 a[38:39], v13 offset:1024
    ds_read_b64_tr_b16 a[40:41], v14 offset:0
    ds_read_b64_tr_b16 a[42:43], v14 offset:1024
    ds_read_b64_tr_b16 a[44:45], v15 offset:0
    ds_read_b64_tr_b16 a[46:47], v15 offset:1024
    v_lshlrev_b32 v48, 16, v20
    v_and_b32 v49, 0xffff0000, v20
    v_lshlrev_b32 v50, 16, v21
    v_and_b32 v51, 0xffff0000, v21
    v_sub_f32 v48, v48, v2
    v_sub_f32 v49, v49, v2
    v_sub_f32 v50, v50, v2
    v_sub_f32 v51, v51, v2
    v_mul_f32_dpp v48, v18, v48 row_newbcast:0 row_mask:0xf bank_mask:0xf
    v_mul_f32_dpp v49, v19, v49 row_newbcast:0 row_mask:0xf bank_mask:0xf
    v_mfma_f32_32x32x16_bf16 v[88:103], a[52:55], v[44:47], v[88:103]
    v_mul_f32_dpp v50, v18, v50 row_newbcast:1 row_mask:0xf bank_mask:0xf
    v_mul_f32_dpp v51, v19, v51 row_newbcast:1 row_mask:0xf bank_mask:0xf
    v_cvt_pk_bf16_f32 v40, v48, v49
    v_cvt_pk_bf16_f32 v41, v50, v51
    v_lshlrev_b32 v52, 16, v22
    v_and_b32 v53, 0xffff0000, v22
    v_lshlrev_b32 v54, 16, v23
    v_and_b32 v55, 0xffff0000, v23
    v_sub_f32 v52, v52, v2
    v_sub_f32 v53, v53, v2
    v_mfma_f32_32x32x16_bf16 a[0:15], a[56:59], v[44:47], a[0:15]
    v_sub_f32 v54, v54, v2
    v_sub_f32 v55, v55, v2
    v_mul_f32_dpp v52, v18, v52 row_newbcast:2 row_mask:0xf bank_mask:0xf
    v_mul_f32_dpp v53, v19, v53 row_newbcast:2 row_mask:0xf bank_mask:0xf
    v_mul_f32_dpp v54, v18, v54 row_newbcast:3 row_mask:0xf bank_mask:0xf
    v_mul_f32_dpp v55, v19, v55 row_newbcast:3 row_mask:0xf bank_mask:0xf
    v_cvt_pk_bf16_f32 v42, v52, v53
    v_cvt_pk_bf16_f32 v43, v54, v55
    v_mfma_f32_32x32x16_bf16 a[16:31], a[60:63], v[44:47], a[16:31]
    v_lshlrev_b32 v16, 16, v62
    v_and_b32 v17, 0xffff0000, v62
    s_waitcnt lgkmcnt(0)
    s_setprio 0
    s_cmp_eq_u32 s41, 0
    s_cbranch_scc0 L_als21
    s_setprio 1
L_als21:
    v_mfma_f32_32x32x16_bf16 v[72:87], a[32:35], v[40:43], v[72:87]
    ds_read_b128 v[20:23], v5 offset:0
    ds_read_b64_tr_b16 a[48:49], v12 offset:4096
    ds_read_b64_tr_b16 a[50:51], v12 offset:5120
    ds_read_b64_tr_b16 a[52:53], v13 offset:4096
    ds_read_b64_tr_b16 a[54:55], v13 offset:5120
    ds_read_b64_tr_b16 a[56:57], v14 offset:4096
    ds_read_b64_tr_b16 a[58:59], v14 offset:5120
    ds_read_b64_tr_b16 a[60:61], v15 offset:4096
    ds_read_b64_tr_b16 a[62:63], v15 offset:5120
    v_lshlrev_b32 v48, 16, v24
    v_and_b32 v49, 0xffff0000, v24
    v_lshlrev_b32 v50, 16, v25
    v_and_b32 v51, 0xffff0000, v25
    v_sub_f32 v48, v48, v2
    v_sub_f32 v49, v49, v2
    v_sub_f32 v50, v50, v2
    v_sub_f32 v51, v51, v2
    v_mul_f32_dpp v48, v18, v48 row_newbcast:4 row_mask:0xf bank_mask:0xf
    v_mul_f32_dpp v49, v19, v49 row_newbcast:4 row_mask:0xf bank_mask:0xf
    v_mfma_f32_32x32x16_bf16 v[88:103], a[36:39], v[40:43], v[88:103]
    v_mul_f32_dpp v50, v18, v50 row_newbcast:5 row_mask:0xf bank_mask:0xf
    v_mul_f32_dpp v51, v19, v51 row_newbcast:5 row_mask:0xf bank_mask:0xf
    v_cvt_pk_bf16_f32 v44, v48, v49
    v_cvt_pk_bf16_f32 v45, v50, v51
    v_lshlrev_b32 v52, 16, v26
    v_and_b32 v53, 0xffff0000, v26
    v_lshlrev_b32 v54, 16, v27
    v_and_b32 v55, 0xffff0000, v27
    v_sub_f32 v52, v52, v2
    v_sub_f32 v53, v53, v2
    v_mfma_f32_32x32x16_bf16 a[0:15], a[40:43], v[40:43], a[0:15]
    v_sub_f32 v54, v54, v2
    v_sub_f32 v55, v55, v2
    v_mul_f32_dpp v52, v18, v52 row_newbcast:6 row_mask:0xf bank_mask:0xf
    v_mul_f32_dpp v53, v19, v53 row_newbcast:6 row_mask:0xf bank_mask:0xf
    v_mul_f32_dpp v54, v18, v54 row_newbcast:7 row_mask:0xf bank_mask:0xf
    v_mul_f32_dpp v55, v19, v55 row_newbcast:7 row_mask:0xf bank_mask:0xf
    v_cvt_pk_bf16_f32 v46, v52, v53
    v_cvt_pk_bf16_f32 v47, v54, v55
    v_mfma_f32_32x32x16_bf16 a[16:31], a[44:47], v[40:43], a[16:31]
    s_waitcnt lgkmcnt(0)
    v_mfma_f32_32x32x16_bf16 v[72:87], a[48:51], v[44:47], v[72:87]
    ds_read_b128 v[24:27], v6 offset:0
    ds_read_b64_tr_b16 a[32:33], v12 offset:8192
    ds_read_b64_tr_b16 a[34:35], v12 offset:9216
    ds_read_b64_tr_b16 a[36:37], v13 offset:8192
    ds_read_b64_tr_b16 a[38:39], v13 offset:9216
    ds_read_b64_tr_b16 a[40:41], v14 offset:8192
    ds_read_b64_tr_b16 a[42:43], v14 offset:9216
    ds_read_b64_tr_b16 a[44:45], v15 offset:8192
    ds_read_b64_tr_b16 a[46:47], v15 offset:9216
    v_lshlrev_b32 v48, 16, v28
    v_and_b32 v49, 0xffff0000, v28
    v_lshlrev_b32 v50, 16, v29
    v_and_b32 v51, 0xffff0000, v29
    v_sub_f32 v48, v48, v2
    v_sub_f32 v49, v49, v2
    v_sub_f32 v50, v50, v2
    v_sub_f32 v51, v51, v2
    v_mul_f32_dpp v48, v18, v48 row_newbcast:8 row_mask:0xf bank_mask:0xf
    v_mul_f32_dpp v49, v19, v49 row_newbcast:8 row_mask:0xf bank_mask:0xf
    v_mfma_f32_32x32x16_bf16 v[88:103], a[52:55], v[44:47], v[88:103]
    v_mul_f32_dpp v50, v18, v50 row_newbcast:9 row_mask:0xf bank_mask:0xf
    v_mul_f32_dpp v51, v19, v51 row_newbcast:9 row_mask:0xf bank_mask:0xf
    v_cvt_pk_bf16_f32 v40, v48, v49
    v_cvt_pk_bf16_f32 v41, v50, v51
    v_lshlrev_b32 v52, 16, v30
    v_and_b32 v53, 0xffff0000, v30
    v_lshlrev_b32 v54, 16, v31
    v_and_b32 v55, 0xffff0000, v31
    v_sub_f32 v52, v52, v2
    v_sub_f32 v53, v53, v2
    v_mfma_f32_32x32x16_bf16 a[0:15], a[56:59], v[44:47], a[0:15]
    v_sub_f32 v54, v54, v2
    v_sub_f32 v55, v55, v2
    v_mul_f32_dpp v52, v18, v52 row_newbcast:10 row_mask:0xf bank_mask:0xf
    v_mul_f32_dpp v53, v19, v53 row_newbcast:10 row_mask:0xf bank_mask:0xf
    v_mul_f32_dpp v54, v18, v54 row_newbcast:11 row_mask:0xf bank_mask:0xf
    v_mul_f32_dpp v55, v19, v55 row_newbcast:11 row_mask:0xf bank_mask:0xf
    v_cvt_pk_bf16_f32 v42, v52, v53
    v_cvt_pk_bf16_f32 v43, v54, v55
    v_mfma_f32_32x32x16_bf16 a[16:31], a[60:63], v[44:47], a[16:31]
    s_waitcnt lgkmcnt(0)
    s_setprio 0
    s_cmp_eq_u32 s41, 1
    s_cbranch_scc0 L_als23
    s_setprio 1
L_als23:
    v_mfma_f32_32x32x16_bf16 v[72:87], a[32:35], v[40:43], v[72:87]
    ds_read_b128 v[28:31], v7 offset:0
    ds_read_b64_tr_b16 a[48:49], v12 offset:12288
    ds_read_b64_tr_b16 a[50:51], v12 offset:13312
    ds_read_b64_tr_b16 a[52:53], v13 offset:12288
    ds_read_b64_tr_b16 a[54:55], v13 offset:13312
    ds_read_b64_tr_b16 a[56:57], v14 offset:12288
    ds_read_b64_tr_b16 a[58:59], v14 offset:13312
    ds_read_b64_tr_b16 a[60:61], v15 offset:12288
    ds_read_b64_tr_b16 a[62:63], v15 offset:13312
    v_lshlrev_b32 v48, 16, v32
    v_and_b32 v49, 0xffff0000, v32
    v_lshlrev_b32 v50, 16, v33
    v_and_b32 v51, 0xffff0000, v33
    v_sub_f32 v48, v48, v2
    v_sub_f32 v49, v49, v2
    v_sub_f32 v50, v50, v2
    v_sub_f32 v51, v51, v2
    v_mul_f32_dpp v48, v18, v48 row_newbcast:12 row_mask:0xf bank_mask:0xf
    v_mul_f32_dpp v49, v19, v49 row_newbcast:12 row_mask:0xf bank_mask:0xf
    v_mfma_f32_32x32x16_bf16 v[88:103], a[36:39], v[40:43], v[88:103]
    v_mul_f32_dpp v50, v18, v50 row_newbcast:13 row_mask:0xf bank_mask:0xf
    v_mul_f32_dpp v51, v19, v51 row_newbcast:13 row_mask:0xf bank_mask:0xf
    v_cvt_pk_bf16_f32 v44, v48, v49
    v_cvt_pk_bf16_f32 v45, v50, v51
    v_lshlrev_b32 v52, 16, v34
    v_and_b32 v53, 0xffff0000, v34
    v_lshlrev_b32 v54, 16, v35
    v_and_b32 v55, 0xffff0000, v35
    v_sub_f32 v52, v52, v2
    v_sub_f32 v53, v53, v2
    v_mfma_f32_32x32x16_bf16 a[0:15], a[40:43], v[40:43], a[0:15]
    v_sub_f32 v54, v54, v2
    v_sub_f32 v55, v55, v2
    v_mul_f32_dpp v52, v18, v52 row_newbcast:14 row_mask:0xf bank_mask:0xf
    v_mul_f32_dpp v53, v19, v53 row_newbcast:14 row_mask:0xf bank_mask:0xf
    v_mul_f32_dpp v54, v18, v54 row_newbcast:15 row_mask:0xf bank_mask:0xf
    v_mul_f32_dpp v55, v19, v55 row_newbcast:15 row_mask:0xf bank_mask:0xf
    v_cvt_pk_bf16_f32 v46, v52, v53
    v_cvt_pk_bf16_f32 v47, v54, v55
    v_mfma_f32_32x32x16_bf16 a[16:31], a[44:47], v[40:43], a[16:31]
    s_waitcnt lgkmcnt(0)
    s_barrier
    v_mfma_f32_32x32x16_bf16 v[72:87], a[48:51], v[44:47], v[72:87]
    ds_read_b128 v[32:35], v4 offset:4096
    ds_read_b64_tr_b16 a[32:33], v8 offset:0
    ds_read_b64_tr_b16 a[34:35], v8 offset:1024
    ds_read_b64_tr_b16 a[36:37], v9 offset:0
    ds_read_b64_tr_b16 a[38:39], v9 offset:1024
    ds_read_b64_tr_b16 a[40:41], v10 offset:0
    ds_read_b64_tr_b16 a[42:43], v10 offset:1024
    ds_read_b64_tr_b16 a[44:45], v11 offset:0
    ds_read_b64_tr_b16 a[46:47], v11 offset:1024
    v_lshlrev_b32 v48, 16, v36
    v_and_b32 v49, 0xffff0000, v36
    v_lshlrev_b32 v50, 16, v37
    v_and_b32 v51, 0xffff0000, v37
    v_sub_f32 v48, v48, v2
    v_sub_f32 v49, v49, v2
    v_sub_f32 v50, v50, v2
    v_sub_f32 v51, v51, v2
    v_mul_f32_dpp v48, v16, v48 row_newbcast:0 row_mask:0xf bank_mask:0xf
    v_mul_f32_dpp v49, v17, v49 row_newbcast:0 row_mask:0xf bank_mask:0xf
    v_mfma_f32_32x32x16_bf16 v[88:103], a[52:55], v[44:47], v[88:103]
    v_mul_f32_dpp v50, v16, v50 row_newbcast:1 row_mask:0xf bank_mask:0xf
    v_mul_f32_dpp v51, v17, v51 row_newbcast:1 row_mask:0xf bank_mask:0xf
    v_cvt_pk_bf16_f32 v40, v48, v49
    v_cvt_pk_bf16_f32 v41, v50, v51
    v_lshlrev_b32 v52, 16, v38
    v_and_b32 v53, 0xffff0000, v38
    v_lshlrev_b32 v54, 16, v39
    v_and_b32 v55, 0xffff0000, v39
    v_sub_f32 v52, v52, v2
    v_sub_f32 v53, v53, v2
    v_mfma_f32_32x32x16_bf16 a[0:15], a[56:59], v[44:47], a[0:15]
    v_sub_f32 v54, v54, v2
    v_sub_f32 v55, v55, v2
    v_mul_f32_dpp v52, v16, v52 row_newbcast:2 row_mask:0xf bank_mask:0xf
    v_mul_f32_dpp v53, v17, v53 row_newbcast:2 row_mask:0xf bank_mask:0xf
    v_mul_f32_dpp v54, v16, v54 row_newbcast:3 row_mask:0xf bank_mask:0xf
    v_mul_f32_dpp v55, v17, v55 row_newbcast:3 row_mask:0xf bank_mask:0xf
    v_cvt_pk_bf16_f32 v42, v52, v53
    v_cvt_pk_bf16_f32 v43, v54, v55
    v_mfma_f32_32x32x16_bf16 a[16:31], a[60:63], v[44:47], a[16:31]
    v_lshlrev_b32 v18, 16, v63
    v_and_b32 v19, 0xffff0000, v63
    s_waitcnt lgkmcnt(0)
    s_setprio 0
    s_cmp_eq_u32 s41, 0
    s_cbranch_scc0 L_als25
    s_setprio 1
L_als25:
    v_mfma_f32_32x32x16_bf16 v[72:87], a[32:35], v[40:43], v[72:87]
    ds_read_b128 v[36:39], v5 offset:4096
    ds_read_b64_tr_b16 a[48:49], v8 offset:4096
    ds_read_b64_tr_b16 a[50:51], v8 offset:5120
    ds_read_b64_tr_b16 a[52:53], v9 offset:4096
    ds_read_b64_tr_b16 a[54:55], v9 offset:5120
    ds_read_b64_tr_b16 a[56:57], v10 offset:4096
    ds_read_b64_tr_b16 a[58:59], v10 offset:5120
    ds_read_b64_tr_b16 a[60:61], v11 offset:4096
    ds_read_b64_tr_b16 a[62:63], v11 offset:5120
    v_lshlrev_b32 v48, 16, v20
    v_and_b32 v49, 0xffff0000, v20
    v_lshlrev_b32 v50, 16, v21
    v_and_b32 v51, 0xffff0000, v21
    v_sub_f32 v48, v48, v2
    v_sub_f32 v49, v49, v2
    v_sub_f32 v50, v50, v2
    v_sub_f32 v51, v51, v2
    v_mul_f32_dpp v48, v16, v48 row_newbcast:4 row_mask:0xf bank_mask:0xf
    v_mul_f32_dpp v49, v17, v49 row_newbcast:4 row_mask:0xf bank_mask:0xf
    v_mfma_f32_32x32x16_bf16 v[88:103], a[36:39], v[40:43], v[88:103]
    v_mul_f32_dpp v50, v16, v50 row_newbcast:5 row_mask:0xf bank_mask:0xf
    v_mul_f32_dpp v51, v17, v51 row_newbcast:5 row_mask:0xf bank_mask:0xf
    v_cvt_pk_bf16_f32 v44, v48, v49
    v_cvt_pk_bf16_f32 v45, v50, v51
    v_lshlrev_b32 v52, 16, v22
    v_and_b32 v53, 0xffff0000, v22
    v_lshlrev_b32 v54, 16, v23
    v_and_b32 v55, 0xffff0000, v23
    v_sub_f32 v52, v52, v2
    v_sub_f32 v53, v53, v2
    v_mfma_f32_32x32x16_bf16 a[0:15], a[40:43], v[40:43], a[0:15]
    v_sub_f32 v54, v54, v2
    v_sub_f32 v55, v55, v2
    v_mul_f32_dpp v52, v16, v52 row_newbcast:6 row_mask:0xf bank_mask:0xf
    v_mul_f32_dpp v53, v17, v53 row_newbcast:6 row_mask:0xf bank_mask:0xf
    v_mul_f32_dpp v54, v16, v54 row_newbcast:7 row_mask:0xf bank_mask:0xf
    v_mul_f32_dpp v55, v17, v55 row_newbcast:7 row_mask:0xf bank_mask:0xf
    v_cvt_pk_bf16_f32 v46, v52, v53
    v_cvt_pk_bf16_f32 v47, v54, v55
    v_mfma_f32_32x32x16_bf16 a[16:31], a[44:47], v[40:43], a[16:31]
    v_and_b32 v48, 31, v1
    v_lshrrev_b32 v49, 5, v1
    s_lshl_b32 s46, s40, 9
    s_add_u32 s46, s46, 98304
    v_lshl_add_u32 v13, v48, 4, s46
    s_lshl_b32 s46, s40, 7
    s_add_u32 s46, s46, 106496
    v_lshl_add_u32 v12, v48, 2, s46
    s_lshl_b32 s47, s41, 9
    v_add_u32 v15, s47, v12
    v_lshl_add_u32 v12, v49, 9, v12
    s_lshl_b32 s46, s41, 8
    s_add_u32 s46, s46, 100352
    v_lshl_add_u32 v14, v48, 2, s46
    v_lshl_add_u32 v14, v49, 9, v14
    s_waitcnt lgkmcnt(0)
    v_mfma_f32_32x32x16_bf16 v[72:87], a[48:51], v[44:47], v[72:87]
    ds_read_b128 v[20:23], v6 offset:4096
    ds_read_b64_tr_b16 a[32:33], v8 offset:8192
    ds_read_b64_tr_b16 a[34:35], v8 offset:9216
    ds_read_b64_tr_b16 a[36:37], v9 offset:8192
    ds_read_b64_tr_b16 a[38:39], v9 offset:9216
    ds_read_b64_tr_b16 a[40:41], v10 offset:8192
    ds_read_b64_tr_b16 a[42:43], v10 offset:9216
    ds_read_b64_tr_b16 a[44:45], v11 offset:8192
    ds_read_b64_tr_b16 a[46:47], v11 offset:9216
    v_lshlrev_b32 v48, 16, v24
    v_and_b32 v49, 0xffff0000, v24
    v_lshlrev_b32 v50, 16, v25
    v_and_b32 v51, 0xffff0000, v25
    v_sub_f32 v48, v48, v2
    v_sub_f32 v49, v49, v2
    v_sub_f32 v50, v50, v2
    v_sub_f32 v51, v51, v2
    v_mul_f32_dpp v48, v16, v48 row_newbcast:8 row_mask:0xf bank_mask:0xf
    v_mul_f32_dpp v49, v17, v49 row_newbcast:8 row_mask:0xf bank_mask:0xf
    v_mfma_f32_32x32x16_bf16 v[88:103], a[52:55], v[44:47], v[88:103]
    v_mul_f32_dpp v50, v16, v50 row_newbcast:9 row_mask:0xf bank_mask:0xf
    v_mul_f32_dpp v51, v17, v51 row_newbcast:9 row_mask:0xf bank_mask:0xf
    v_cvt_pk_bf16_f32 v40, v48, v49
    v_cvt_pk_bf16_f32 v41, v50, v51
    v_lshlrev_b32 v52, 16, v26
    v_and_b32 v53, 0xffff0000, v26
    v_lshlrev_b32 v54, 16, v27
    v_and_b32 v55, 0xffff0000, v27
    v_sub_f32 v52, v52, v2
    v_sub_f32 v53, v53, v2
    v_mfma_f32_32x32x16_bf16 a[0:15], a[56:59], v[44:47], a[0:15]
    v_sub_f32 v54, v54, v2
    v_sub_f32 v55, v55, v2
    v_mul_f32_dpp v52, v16, v52 row_newbcast:10 row_mask:0xf bank_mask:0xf
    v_mul_f32_dpp v53, v17, v53 row_newbcast:10 row_mask:0xf bank_mask:0xf
    v_mul_f32_dpp v54, v16, v54 row_newbcast:11 row_mask:0xf bank_mask:0xf
    v_mul_f32_dpp v55, v17, v55 row_newbcast:11 row_mask:0xf bank_mask:0xf
    v_cvt_pk_bf16_f32 v42, v52, v53
    v_cvt_pk_bf16_f32 v43, v54, v55
    v_mfma_f32_32x32x16_bf16 a[16:31], a[60:63], v[44:47], a[16:31]
    s_waitcnt lgkmcnt(0)
    s_setprio 0
    s_cmp_eq_u32 s41, 1
    s_cbranch_scc0 L_als27
    s_setprio 1
L_als27:
    v_mfma_f32_32x32x16_bf16 v[72:87], a[32:35], v[40:43], v[72:87]
    ds_read_b128 v[24:27], v7 offset:4096
    ds_read_b64_tr_b16 a[48:49], v8 offset:12288
    ds_read_b64_tr_b16 a[50:51], v8 offset:13312
    ds_read_b64_tr_b16 a[52:53], v9 offset:12288
    ds_read_b64_tr_b16 a[54:55], v9 offset:13312
    ds_read_b64_tr_b16 a[56:57], v10 offset:12288
    ds_read_b64_tr_b16 a[58:59], v10 offset:13312
    ds_read_b64_tr_b16 a[60:61], v11 offset:12288
    ds_read_b64_tr_b16 a[62:63], v11 offset:13312
    v_lshlrev_b32 v48, 16, v28
    v_and_b32 v49, 0xffff0000, v28
    v_lshlrev_b32 v50, 16, v29
    v_and_b32 v51, 0xffff0000, v29
    v_sub_f32 v48, v48, v2
    v_sub_f32 v49, v49, v2
    v_sub_f32 v50, v50, v2
    v_sub_f32 v51, v51, v2
    v_mul_f32_dpp v48, v16, v48 row_newbcast:12 row_mask:0xf bank_mask:0xf
    v_mul_f32_dpp v49, v17, v49 row_newbcast:12 row_mask:0xf bank_mask:0xf
    v_mfma_f32_32x32x16_bf16 v[88:103], a[36:39], v[40:43], v[88:103]
    v_mul_f32_dpp v50, v16, v50 row_newbcast:13 row_mask:0xf bank_mask:0xf
    v_mul_f32_dpp v51, v17, v51 row_newbcast:13 row_mask:0xf bank_mask:0xf
    v_cvt_pk_bf16_f32 v44, v48, v49
    v_cvt_pk_bf16_f32 v45, v50, v51
    v_lshlrev_b32 v52, 16, v30
    v_and_b32 v53, 0xffff0000, v30
    v_lshlrev_b32 v54, 16, v31
    v_and_b32 v55, 0xffff0000, v31
    v_sub_f32 v52, v52, v2
    v_sub_f32 v53, v53, v2
    v_mfma_f32_32x32x16_bf16 a[0:15], a[40:43], v[40:43], a[0:15]
    v_sub_f32 v54, v54, v2
    v_sub_f32 v55, v55, v2
    v_mul_f32_dpp v52, v16, v52 row_newbcast:14 row_mask:0xf bank_mask:0xf
    v_mul_f32_dpp v53, v17, v53 row_newbcast:14 row_mask:0xf bank_mask:0xf
    v_mul_f32_dpp v54, v16, v54 row_newbcast:15 row_mask:0xf bank_mask:0xf
    v_mul_f32_dpp v55, v17, v55 row_newbcast:15 row_mask:0xf bank_mask:0xf
    v_cvt_pk_bf16_f32 v46, v52, v53
    v_cvt_pk_bf16_f32 v47, v54, v55
    v_mfma_f32_32x32x16_bf16 a[16:31], a[44:47], v[40:43], a[16:31]
    s_waitcnt lgkmcnt(0)
    s_barrier
    v_mfma_f32_32x32x16_bf16 v[72:87], a[48:51], v[44:47], v[72:87]
    ds_read_b64_tr_b16 a[32:33], v8 offset:32768
    ds_read_b64_tr_b16 a[34:35], v8 offset:33792
    ds_read_b64_tr_b16 a[36:37], v9 offset:32768
    ds_read_b64_tr_b16 a[38:39], v9 offset:33792
    ds_read_b64_tr_b16 a[40:41], v10 offset:32768
    ds_read_b64_tr_b16 a[42:43], v10 offset:33792
    ds_read_b64_tr_b16 a[44:45], v11 offset:32768
    ds_read_b64_tr_b16 a[46:47], v11 offset:33792
    v_lshlrev_b32 v48, 16, v32
    v_and_b32 v49, 0xffff0000, v32
    v_lshlrev_b32 v50, 16, v33
    v_and_b32 v51, 0xffff0000, v33
    v_sub_f32 v48, v48, v2
    v_sub_f32 v49, v49, v2
    v_sub_f32 v50, v50, v2
    v_sub_f32 v51, v51, v2
    v_mul_f32_dpp v48, v18, v48 row_newbcast:0 row_mask:0xf bank_mask:0xf
    v_mul_f32_dpp v49, v19, v49 row_newbcast:0 row_mask:0xf bank_mask:0xf
    v_mfma_f32_32x32x16_bf16 v[88:103], a[52:55], v[44:47], v[88:103]
    v_mul_f32_dpp v50, v18, v50 row_newbcast:1 row_mask:0xf bank_mask:0xf
    v_mul_f32_dpp v51, v19, v51 row_newbcast:1 row_mask:0xf bank_mask:0xf
    v_cvt_pk_bf16_f32 v40, v48, v49
    v_cvt_pk_bf16_f32 v41, v50, v51
    v_lshlrev_b32 v52, 16, v34
    v_and_b32 v53, 0xffff0000, v34
    v_lshlrev_b32 v54, 16, v35
    v_and_b32 v55, 0xffff0000, v35
    v_sub_f32 v52, v52, v2
    v_sub_f32 v53, v53, v2
    v_mfma_f32_32x32x16_bf16 a[0:15], a[56:59], v[44:47], a[0:15]
    v_sub_f32 v54, v54, v2
    v_sub_f32 v55, v55, v2
    v_mul_f32_dpp v52, v18, v52 row_newbcast:2 row_mask:0xf bank_mask:0xf
    v_mul_f32_dpp v53, v19, v53 row_newbcast:2 row_mask:0xf bank_mask:0xf
    v_mul_f32_dpp v54, v18, v54 row_newbcast:3 row_mask:0xf bank_mask:0xf
    v_mul_f32_dpp v55, v19, v55 row_newbcast:3 row_mask:0xf bank_mask:0xf
    v_cvt_pk_bf16_f32 v42, v52, v53
    v_cvt_pk_bf16_f32 v43, v54, v55
    v_mfma_f32_32x32x16_bf16 a[16:31], a[60:63], v[44:47], a[16:31]
    s_waitcnt lgkmcnt(0)
    s_setprio 0
    s_cmp_eq_u32 s41, 0
    s_cbranch_scc0 L_als29
    s_setprio 1
L_als29:
    v_mfma_f32_32x32x16_bf16 v[72:87], a[32:35], v[40:43], v[72:87]
    ds_read_b64_tr_b16 a[48:49], v8 offset:36864
    ds_read_b64_tr_b16 a[50:51], v8 offset:37888
    ds_read_b64_tr_b16 a[52:53], v9 offset:36864
    ds_read_b64_tr_b16 a[54:55], v9 offset:37888
    ds_read_b64_tr_b16 a[56:57], v10 offset:36864
    ds_read_b64_tr_b16 a[58:59], v10 offset:37888
    ds_read_b64_tr_b16 a[60:61], v11 offset:36864
    ds_read_b64_tr_b16 a[62:63], v11 offset:37888
    v_lshlrev_b32 v48, 16, v36
    v_and_b32 v49, 0xffff0000, v36
    v_lshlrev_b32 v50, 16, v37
    v_and_b32 v51, 0xffff0000, v37
    v_sub_f32 v48, v48, v2
    v_sub_f32 v49, v49, v2
    v_sub_f32 v50, v50, v2
    v_sub_f32 v51, v51, v2
    v_mul_f32_dpp v48, v18, v48 row_newbcast:4 row_mask:0xf bank_mask:0xf
    v_mul_f32_dpp v49, v19, v49 row_newbcast:4 row_mask:0xf bank_mask:0xf
    v_mfma_f32_32x32x16_bf16 v[88:103], a[36:39], v[40:43], v[88:103]
    v_mul_f32_dpp v50, v18, v50 row_newbcast:5 row_mask:0xf bank_mask:0xf
    v_mul_f32_dpp v51, v19, v51 row_newbcast:5 row_mask:0xf bank_mask:0xf
    v_cvt_pk_bf16_f32 v44, v48, v49
    v_cvt_pk_bf16_f32 v45, v50, v51
    v_lshlrev_b32 v52, 16, v38
    v_and_b32 v53, 0xffff0000, v38
    v_lshlrev_b32 v54, 16, v39
    v_and_b32 v55, 0xffff0000, v39
    v_sub_f32 v52, v52, v2
    v_sub_f32 v53, v53, v2
    v_mfma_f32_32x32x16_bf16 a[0:15], a[40:43], v[40:43], a[0:15]
    v_sub_f32 v54, v54, v2
    v_sub_f32 v55, v55, v2
    v_mul_f32_dpp v52, v18, v52 row_newbcast:6 row_mask:0xf bank_mask:0xf
    v_mul_f32_dpp v53, v19, v53 row_newbcast:6 row_mask:0xf bank_mask:0xf
    v_mul_f32_dpp v54, v18, v54 row_newbcast:7 row_mask:0xf bank_mask:0xf
    v_mul_f32_dpp v55, v19, v55 row_newbcast:7 row_mask:0xf bank_mask:0xf
    v_cvt_pk_bf16_f32 v46, v52, v53
    v_cvt_pk_bf16_f32 v47, v54, v55
    v_mfma_f32_32x32x16_bf16 a[16:31], a[44:47], v[40:43], a[16:31]
    ds_write_b32 v15, v2
    s_waitcnt lgkmcnt(0)
    v_mfma_f32_32x32x16_bf16 v[72:87], a[48:51], v[44:47], v[72:87]
    ds_read_b64_tr_b16 a[32:33], v8 offset:40960
    ds_read_b64_tr_b16 a[34:35], v8 offset:41984
    ds_read_b64_tr_b16 a[36:37], v9 offset:40960
    ds_read_b64_tr_b16 a[38:39], v9 offset:41984
    ds_read_b64_tr_b16 a[40:41], v10 offset:40960
    ds_read_b64_tr_b16 a[42:43], v10 offset:41984
    ds_read_b64_tr_b16 a[44:45], v11 offset:40960
    ds_read_b64_tr_b16 a[46:47], v11 offset:41984
    v_lshlrev_b32 v48, 16, v20
    v_and_b32 v49, 0xffff0000, v20
    v_lshlrev_b32 v50, 16, v21
    v_and_b32 v51, 0xffff0000, v21
    v_sub_f32 v48, v48, v2
    v_sub_f32 v49, v49, v2
    v_sub_f32 v50, v50, v2
    v_sub_f32 v51, v51, v2
    v_mul_f32_dpp v48, v18, v48 row_newbcast:8 row_mask:0xf bank_mask:0xf
    v_mul_f32_dpp v49, v19, v49 row_newbcast:8 row_mask:0xf bank_mask:0xf
    v_mfma_f32_32x32x16_bf16 v[88:103], a[52:55], v[44:47], v[88:103]
    v_mul_f32_dpp v50, v18, v50 row_newbcast:9 row_mask:0xf bank_mask:0xf
    v_mul_f32_dpp v51, v19, v51 row_newbcast:9 row_mask:0xf bank_mask:0xf
    v_cvt_pk_bf16_f32 v40, v48, v49
    v_cvt_pk_bf16_f32 v41, v50, v51
    v_lshlrev_b32 v52, 16, v22
    v_and_b32 v53, 0xffff0000, v22
    v_lshlrev_b32 v54, 16, v23
    v_and_b32 v55, 0xffff0000, v23
    v_sub_f32 v52, v52, v2
    v_sub_f32 v53, v53, v2
    v_mfma_f32_32x32x16_bf16 a[0:15], a[56:59], v[44:47], a[0:15]
    v_sub_f32 v54, v54, v2
    v_sub_f32 v55, v55, v2
    v_mul_f32_dpp v52, v18, v52 row_newbcast:10 row_mask:0xf bank_mask:0xf
    v_mul_f32_dpp v53, v19, v53 row_newbcast:10 row_mask:0xf bank_mask:0xf
    v_mul_f32_dpp v54, v18, v54 row_newbcast:11 row_mask:0xf bank_mask:0xf
    v_mul_f32_dpp v55, v19, v55 row_newbcast:11 row_mask:0xf bank_mask:0xf
    v_cvt_pk_bf16_f32 v42, v52, v53
    v_cvt_pk_bf16_f32 v43, v54, v55
    v_mfma_f32_32x32x16_bf16 a[16:31], a[60:63], v[44:47], a[16:31]
    s_waitcnt lgkmcnt(0)
    s_setprio 0
    s_cmp_eq_u32 s41, 1
    s_cbranch_scc0 L_als31
    s_setprio 1
L_als31:
    v_mfma_f32_32x32x16_bf16 v[72:87], a[32:35], v[40:43], v[72:87]
    ds_read_b64_tr_b16 a[48:49], v8 offset:45056
    ds_read_b64_tr_b16 a[50:51], v8 offset:46080
    ds_read_b64_tr_b16 a[52:53], v9 offset:45056
    ds_read_b64_tr_b16 a[54:55], v9 offset:46080
    ds_read_b64_tr_b16 a[56:57], v10 offset:45056
    ds_read_b64_tr_b16 a[58:59], v10 offset:46080
    ds_read_b64_tr_b16 a[60:61], v11 offset:45056
    ds_read_b64_tr_b16 a[62:63], v11 offset:46080
    v_lshlrev_b32 v48, 16, v24
    v_and_b32 v49, 0xffff0000, v24
    v_lshlrev_b32 v50, 16, v25
    v_and_b32 v51, 0xffff0000, v25
    v_sub_f32 v48, v48, v2
    v_sub_f32 v49, v49, v2
    v_sub_f32 v50, v50, v2
    v_sub_f32 v51, v51, v2
    v_mul_f32_dpp v48, v18, v48 row_newbcast:12 row_mask:0xf bank_mask:0xf
    v_mul_f32_dpp v49, v19, v49 row_newbcast:12 row_mask:0xf bank_mask:0xf
    v_mfma_f32_32x32x16_bf16 v[88:103], a[36:39], v[40:43], v[88:103]
    v_mul_f32_dpp v50, v18, v50 row_newbcast:13 row_mask:0xf bank_mask:0xf
    v_mul_f32_dpp v51, v19, v51 row_newbcast:13 row_mask:0xf bank_mask:0xf
    v_cvt_pk_bf16_f32 v44, v48, v49
    v_cvt_pk_bf16_f32 v45, v50, v51
    v_lshlrev_b32 v52, 16, v26
    v_and_b32 v53, 0xffff0000, v26
    v_lshlrev_b32 v54, 16, v27
    v_and_b32 v55, 0xffff0000, v27
    v_sub_f32 v52, v52, v2
    v_sub_f32 v53, v53, v2
    v_mfma_f32_32x32x16_bf16 a[0:15], a[40:43], v[40:43], a[0:15]
    v_sub_f32 v54, v54, v2
    v_sub_f32 v55, v55, v2
    v_mul_f32_dpp v52, v18, v52 row_newbcast:14 row_mask:0xf bank_mask:0xf
    v_mul_f32_dpp v53, v19, v53 row_newbcast:14 row_mask:0xf bank_mask:0xf
    v_mul_f32_dpp v54, v18, v54 row_newbcast:15 row_mask:0xf bank_mask:0xf
    v_mul_f32_dpp v55, v19, v55 row_newbcast:15 row_mask:0xf bank_mask:0xf
    v_cvt_pk_bf16_f32 v46, v52, v53
    v_cvt_pk_bf16_f32 v47, v54, v55
    v_mfma_f32_32x32x16_bf16 a[16:31], a[44:47], v[40:43], a[16:31]
    s_waitcnt lgkmcnt(0)
    v_mfma_f32_32x32x16_bf16 a[0:15], a[56:59], v[44:47], a[0:15]
    v_mfma_f32_32x32x16_bf16 a[16:31], a[60:63], v[44:47], a[16:31]
    v_mfma_f32_32x32x16_bf16 v[72:87], a[48:51], v[44:47], v[72:87]
    v_mfma_f32_32x32x16_bf16 v[88:103], a[52:55], v[44:47], v[88:103]
L_epi:
    v_lshlrev_b32 v55, 4, v1
    s_lshl_b32 s46, s40, 13
    s_lshl_b32 s47, s41, 16
    s_add_u32 s46, s46, s47
    v_add_u32 v56, s46, v55
    s_xor_b32 s46, s46, 0x10000
    v_add_u32 v57, s46, v55
    v_and_b32 v52, 31, v1
    v_lshrrev_b32 v54, 5, v1
    s_nop 1
    ds_write_b128 v56, a[0:3] offset:0
    ds_write_b128 v56, a[4:7] offset:1024
    ds_write_b128 v56, a[8:11] offset:2048
    ds_write_b128 v56, a[12:15] offset:3072
    ds_write_b128 v56, a[16:19] offset:4096
    ds_write_b128 v56, a[20:23] offset:5120
    ds_write_b128 v56, a[24:27] offset:6144
    ds_write_b128 v56, a[28:31] offset:7168
    v_and_b32 v60, 7, v52
    v_xor_b32 v60, v60, v54
    v_lshlrev_b32 v60, 4, v60
    v_lshl_add_u32 v60, v52, 7, v60
    s_add_u32 s46, s44, 4096
    v_add_u32 v60, s46, v60
    v_lshrrev_b32 v61, 3, v1
    v_and_b32 v62, 7, v1
    v_xor_b32 v63, v62, v61
    v_lshlrev_b32 v63, 4, v63
    v_lshl_add_u32 v63, v61, 7, v63
    v_add_u32 v63, s46, v63
    v_lshlrev_b32 v62, 4, v62
    v_lshl_add_u32 v61, v61, 11, v62
    v_xor_b32 v49, 32, v60
    v_xor_b32 v50, 64, v60
    v_xor_b32 v51, 96, v60
    v_lshlrev_b32 v58, 11, v52
    v_lshl_add_u32 v58, v54, 4, v58
    s_lshl_b32 s47, s36, 18
    s_lshl_b32 s48, s37, 8
    s_add_u32 s47, s47, s48
    s_lshl_b32 s48, s41, 7
    s_add_u32 s47, s47, s48
    s_lshl_b32 s48, s40, 16
    s_add_u32 s47, s47, s48
    s_waitcnt lgkmcnt(0)
    s_barrier
    ds_read_b32 v3, v12
    ds_read_b128 v[64:67], v13
    ds_read_b32 v68, v14 offset:0
    ds_read_b32 v69, v14 offset:1024
    ds_read_b32 v70, v14 offset:128
    ds_read_b32 v71, v14 offset:1152
    ds_read_b128 v[16:19], v57 offset:0
    ds_read_b128 v[20:23], v57 offset:1024
    ds_read_b128 v[24:27], v57 offset:2048
    ds_read_b128 v[28:31], v57 offset:3072
    ds_read_b128 v[32:35], v57 offset:4096
    ds_read_b128 v[36:39], v57 offset:5120
    ds_read_b128 v[40:43], v57 offset:6144
    ds_read_b128 v[44:47], v57 offset:7168
    s_waitcnt lgkmcnt(8)
    v_sub_f32 v3, v3, v64
    v_mov_b32 v67, v66
    s_nop 0
    v_mfma_f32_32x32x2_f32 v[72:87], v69, v65, v[72:87]
    v_mfma_f32_32x32x2_f32 v[72:87], v68, v3, v[72:87]
    v_mfma_f32_32x32x2_f32 v[88:103], v71, v65, v[88:103]
    v_mfma_f32_32x32x2_f32 v[88:103], v70, v3, v[88:103]
    s_nop 15
    s_nop 2
    s_waitcnt lgkmcnt(0)
    v_pk_add_f32 v[16:17], v[16:17], v[72:73]
    v_pk_add_f32 v[18:19], v[18:19], v[74:75]
    v_pk_mul_f32 v[16:17], v[16:17], v[66:67]
    v_pk_mul_f32 v[18:19], v[18:19], v[66:67]
    v_cvt_pk_bf16_f32 v4, v16, v17
    v_cvt_pk_bf16_f32 v5, v18, v19
    v_pk_add_f32 v[20:21], v[20:21], v[76:77]
    v_pk_add_f32 v[22:23], v[22:23], v[78:79]
    v_pk_mul_f32 v[20:21], v[20:21], v[66:67]
    v_pk_mul_f32 v[22:23], v[22:23], v[66:67]
    v_cvt_pk_bf16_f32 v6, v20, v21
    v_cvt_pk_bf16_f32 v7, v22, v23
    s_nop 1
    v_permlane32_swap_b32 v4, v6
    v_permlane32_swap_b32 v5, v7
    s_nop 1
    ds_write_b128 v60, v[4:7]
    v_pk_add_f32 v[24:25], v[24:25], v[80:81]
    v_pk_add_f32 v[26:27], v[26:27], v[82:83]
    v_pk_mul_f32 v[24:25], v[24:25], v[66:67]
    v_pk_mul_f32 v[26:27], v[26:27], v[66:67]
    v_cvt_pk_bf16_f32 v8, v24, v25
    v_cvt_pk_bf16_f32 v9, v26, v27
    v_pk_add_f32 v[28:29], v[28:29], v[84:85]
    v_pk_add_f32 v[30:31], v[30:31], v[86:87]
    v_pk_mul_f32 v[28:29], v[28:29], v[66:67]
    v_pk_mul_f32 v[30:31], v[30:31], v[66:67]
    v_cvt_pk_bf16_f32 v10, v28, v29
    v_cvt_pk_bf16_f32 v11, v30, v31
    s_nop 1
    v_permlane32_swap_b32 v8, v10
    v_permlane32_swap_b32 v9, v11
    s_nop 1
    ds_write_b128 v49, v[8:11]
    v_pk_add_f32 v[32:33], v[32:33], v[88:89]
    v_pk_add_f32 v[34:35], v[34:35], v[90:91]
    v_pk_mul_f32 v[32:33], v[32:33], v[66:67]
    v_pk_mul_f32 v[34:35], v[34:35], v[66:67]
    v_cvt_pk_bf16_f32 v4, v32, v33
    v_cvt_pk_bf16_f32 v5, v34, v35
    v_pk_add_f32 v[36:37], v[36:37], v[92:93]
    v_pk_add_f32 v[38:39], v[38:39], v[94:95]
    v_pk_mul_f32 v[36:37], v[36:37], v[66:67]
    v_pk_mul_f32 v[38:39], v[38:39], v[66:67]
    v_cvt_pk_bf16_f32 v6, v36, v37
    v_cvt_pk_bf16_f32 v7, v38, v39
    s_nop 1
    v_permlane32_swap_b32 v4, v6
    v_permlane32_swap_b32 v5, v7
    s_nop 1
    ds_write_b128 v50, v[4:7]
    v_pk_add_f32 v[40:41], v[40:41], v[96:97]
    v_pk_add_f32 v[42:43], v[42:43], v[98:99]
    v_pk_mul_f32 v[40:41], v[40:41], v[66:67]
    v_pk_mul_f32 v[42:43], v[42:43], v[66:67]
    v_cvt_pk_bf16_f32 v8, v40, v41
    v_cvt_pk_bf16_f32 v9, v42, v43
    v_pk_add_f32 v[44:45], v[44:45], v[100:101]
    v_pk_add_f32 v[46:47], v[46:47], v[102:103]
    v_pk_mul_f32 v[44:45], v[44:45], v[66:67]
    v_pk_mul_f32 v[46:47], v[46:47], v[66:67]
    v_cvt_pk_bf16_f32 v10, v44, v45
    v_cvt_pk_bf16_f32 v11, v46, v47
    s_nop 1
    v_permlane32_swap_b32 v8, v10
    v_permlane32_swap_b32 v9, v11
    s_nop 1
    ds_write_b128 v51, v[8:11]
    s_waitcnt lgkmcnt(0)
    ds_read_b128 v[16:19], v63 offset:0
    ds_read_b128 v[20:23], v63 offset:1024
    ds_read_b128 v[24:27], v63 offset:2048
    ds_read_b128 v[28:31], v63 offset:3072
    s_waitcnt lgkmcnt(3)
    buffer_store_dwordx4 v[16:19], v61, s[32:35], s47 offen sc1
    s_waitcnt lgkmcnt(2)
    s_add_u32 s47, s47, 16384
    buffer_store_dwordx4 v[20:23], v61, s[32:35], s47 offen sc1
    s_waitcnt lgkmcnt(1)
    s_add_u32 s47, s47, 16384
    buffer_store_dwordx4 v[24:27], v61, s[32:35], s47 offen sc1
    s_waitcnt lgkmcnt(0)
    s_add_u32 s47, s47, 16384
    buffer_store_dwordx4 v[28:31], v61, s[32:35], s47 offen sc1
    s_endpgm
L_helpers:
    v_lshrrev_b32 v48, 3, v1
    v_lshlrev_b32 v48, 11, v48
    v_and_b32 v49, 7, v1
    v_lshrrev_b32 v50, 4, v1
    v_xor_b32 v49, v49, v50
    v_lshl_add_u32 v2, v49, 4, v48
    v_xor_b32 v3, 64, v2
    v_lshlrev_b32 v48, 11, v50
    v_and_b32 v49, 15, v1
    v_lshlrev_b32 v51, 2, v50
    v_xor_b32 v49, v49, v51
    v_lshl_add_u32 v4, v49, 4, v48
    s_lshl_b32 s43, s36, 18
    s_lshl_b32 s45, s37, 8
    s_waitcnt lgkmcnt(0)
    s_mov_b32 s16, s4
    s_and_b32 s17, s5, 0xffff
    s_mov_b32 s18, 8388608
    s_mov_b32 s19, 0x00020000
    s_mov_b32 s20, s10
    s_and_b32 s21, s11, 0xffff
    s_mov_b32 s22, 2097152
    s_mov_b32 s23, 0x00020000
    s_cmp_eq_u32 s39, 11
    s_cbranch_scc1 L_aux
    s_cmp_eq_u32 s39, 10
    s_cbranch_scc1 L_load2
    s_sub_u32 s40, s39, 8
    s_lshl_b32 s46, s40, 10
    s_add_u32 s43, s43, s46
    s_lshl_b32 s46, s40, 20
    s_add_u32 s45, s45, s46
    s_lshl_b32 s44, s40, 15
    s_add_u32 s44, s44, 98304
    s_lshl_b32 s49, s40, 14
    s_add_u32 s47, s58, 0
    s_and_b32 s47, s47, 7
    s_lshl_b32 s47, s47, 7
    s_add_u32 s47, s47, s43
    s_add_u32 m0, s44, 0
    s_add_u32 s46, s47, 0
    buffer_load_dwordx4 v2, s[16:19], s46 offen lds
    s_add_u32 m0, s44, 1024
    s_add_u32 s46, s47, 16384
    buffer_load_dwordx4 v3, s[16:19], s46 offen lds
    s_add_u32 m0, s44, 2048
    s_add_u32 s46, s47, 32768
    buffer_load_dwordx4 v2, s[16:19], s46 offen lds
    s_add_u32 m0, s44, 3072
    s_add_u32 s46, s47, 49152
    buffer_load_dwordx4 v3, s[16:19], s46 offen lds
    s_add_u32 m0, s44, 8192
    s_add_u32 s46, s47, 65536
    buffer_load_dwordx4 v2, s[16:19], s46 offen lds
    s_add_u32 m0, s44, 9216
    s_add_u32 s46, s47, 81920
    buffer_load_dwordx4 v3, s[16:19], s46 offen lds
    s_add_u32 m0, s44, 10240
    s_add_u32 s46, s47, 98304
    buffer_load_dwordx4 v2, s[16:19], s46 offen lds
    s_add_u32 m0, s44, 11264
    s_add_u32 s46, s47, 114688
    buffer_load_dwordx4 v3, s[16:19], s46 offen lds
    s_add_u32 m0, s44, 16384
    s_add_u32 s46, s47, 131072
    buffer_load_dwordx4 v2, s[16:19], s46 offen lds
    s_add_u32 m0, s44, 17408
    s_add_u32 s46, s47, 147456
    buffer_load_dwordx4 v3, s[16:19], s46 offen lds
    s_add_u32 m0, s44, 18432
    s_add_u32 s46, s47, 163840
    buffer_load_dwordx4 v2, s[16:19], s46 offen lds
    s_add_u32 m0, s44, 19456
    s_add_u32 s46, s47, 180224
    buffer_load_dwordx4 v3, s[16:19], s46 offen lds
    s_add_u32 m0, s44, 24576
    s_add_u32 s46, s47, 196608
    buffer_load_dwordx4 v2, s[16:19], s46 offen lds
    s_add_u32 m0, s44, 25600
    s_add_u32 s46, s47, 212992
    buffer_load_dwordx4 v3, s[16:19], s46 offen lds
    s_add_u32 m0, s44, 26624
    s_add_u32 s46, s47, 229376
    buffer_load_dwordx4 v2, s[16:19], s46 offen lds
    s_add_u32 m0, s44, 27648
    s_add_u32 s46, s47, 245760
    buffer_load_dwordx4 v3, s[16:19], s46 offen lds
    s_add_u32 s47, s58, 0
    s_and_b32 s47, s47, 7
    s_lshl_b32 s47, s47, 17
    s_add_u32 s47, s47, s45
    s_add_u32 m0, s49, 0
    s_add_u32 s46, s47, 0
    buffer_load_dwordx4 v4, s[20:23], s46 offen lds
    s_add_u32 m0, s49, 1024
    s_add_u32 s46, s47, 8192
    buffer_load_dwordx4 v4, s[20:23], s46 offen lds
    s_add_u32 m0, s49, 2048
    s_add_u32 s46, s47, 16384
    buffer_load_dwordx4 v4, s[20:23], s46 offen lds
    s_add_u32 m0, s49, 3072
    s_add_u32 s46, s47, 24576
    buffer_load_dwordx4 v4, s[20:23], s46 offen lds
    s_add_u32 m0, s49, 4096
    s_add_u32 s46, s47, 32768
    buffer_load_dwordx4 v4, s[20:23], s46 offen lds
    s_add_u32 m0, s49, 5120
    s_add_u32 s46, s47, 40960
    buffer_load_dwordx4 v4, s[20:23], s46 offen lds
    s_add_u32 m0, s49, 6144
    s_add_u32 s46, s47, 49152
    buffer_load_dwordx4 v4, s[20:23], s46 offen lds
    s_add_u32 m0, s49, 7168
    s_add_u32 s46, s47, 57344
    buffer_load_dwordx4 v4, s[20:23], s46 offen lds
    s_add_u32 s47, s58, 1
    s_and_b32 s47, s47, 7
    s_lshl_b32 s47, s47, 7
    s_add_u32 s47, s47, s43
    s_add_u32 m0, s44, 4096
    s_add_u32 s46, s47, 0
    buffer_load_dwordx4 v2, s[16:19], s46 offen lds
    s_add_u32 m0, s44, 5120
    s_add_u32 s46, s47, 16384
    buffer_load_dwordx4 v3, s[16:19], s46 offen lds
    s_add_u32 m0, s44, 6144
    s_add_u32 s46, s47, 32768
    buffer_load_dwordx4 v2, s[16:19], s46 offen lds
    s_add_u32 m0, s44, 7168
    s_add_u32 s46, s47, 49152
    buffer_load_dwordx4 v3, s[16:19], s46 offen lds
    s_add_u32 m0, s44, 12288
    s_add_u32 s46, s47, 65536
    buffer_load_dwordx4 v2, s[16:19], s46 offen lds
    s_add_u32 m0, s44, 13312
    s_add_u32 s46, s47, 81920
    buffer_load_dwordx4 v3, s[16:19], s46 offen lds
    s_add_u32 m0, s44, 14336
    s_add_u32 s46, s47, 98304
    buffer_load_dwordx4 v2, s[16:19], s46 offen lds
    s_add_u32 m0, s44, 15360
    s_add_u32 s46, s47, 114688
    buffer_load_dwordx4 v3, s[16:19], s46 offen lds
    s_add_u32 m0, s44, 20480
    s_add_u32 s46, s47, 131072
    buffer_load_dwordx4 v2, s[16:19], s46 offen lds
    s_add_u32 m0, s44, 21504
    s_add_u32 s46, s47, 147456
    buffer_load_dwordx4 v3, s[16:19], s46 offen lds
    s_add_u32 m0, s44, 22528
    s_add_u32 s46, s47, 163840
    buffer_load_dwordx4 v2, s[16:19], s46 offen lds
    s_add_u32 m0, s44, 23552
    s_add_u32 s46, s47, 180224
    buffer_load_dwordx4 v3, s[16:19], s46 offen lds
    s_add_u32 m0, s44, 28672
    s_add_u32 s46, s47, 196608
    buffer_load_dwordx4 v2, s[16:19], s46 offen lds
    s_add_u32 m0, s44, 29696
    s_add_u32 s46, s47, 212992
    buffer_load_dwordx4 v3, s[16:19], s46 offen lds
    s_add_u32 m0, s44, 30720
    s_add_u32 s46, s47, 229376
    buffer_load_dwordx4 v2, s[16:19], s46 offen lds
    s_add_u32 m0, s44, 31744
    s_add_u32 s46, s47, 245760
    buffer_load_dwordx4 v3, s[16:19], s46 offen lds
    s_waitcnt vmcnt(24)
    s_barrier
    s_add_u32 s47, s58, 1
    s_and_b32 s47, s47, 7
    s_lshl_b32 s47, s47, 17
    s_add_u32 s47, s47, s45
    s_add_u32 m0, s49, 32768
    s_add_u32 s46, s47, 0
    buffer_load_dwordx4 v4, s[20:23], s46 offen lds
    s_add_u32 m0, s49, 33792
    s_add_u32 s46, s47, 8192
    buffer_load_dwordx4 v4, s[20:23], s46 offen lds
    s_add_u32 m0, s49, 34816
    s_add_u32 s46, s47, 16384
    buffer_load_dwordx4 v4, s[20:23], s46 offen lds
    s_add_u32 m0, s49, 35840
    s_add_u32 s46, s47, 24576
    buffer_load_dwordx4 v4, s[20:23], s46 offen lds
    s_add_u32 m0, s49, 36864
    s_add_u32 s46, s47, 32768
    buffer_load_dwordx4 v4, s[20:23], s46 offen lds
    s_add_u32 m0, s49, 37888
    s_add_u32 s46, s47, 40960
    buffer_load_dwordx4 v4, s[20:23], s46 offen lds
    s_add_u32 m0, s49, 38912
    s_add_u32 s46, s47, 49152
    buffer_load_dwordx4 v4, s[20:23], s46 offen lds
    s_add_u32 m0, s49, 39936
    s_add_u32 s46, s47, 57344
    buffer_load_dwordx4 v4, s[20:23], s46 offen lds
    s_add_u32 s47, s58, 2
    s_and_b32 s47, s47, 7
    s_lshl_b32 s47, s47, 17
    s_add_u32 s47, s47, s45
    s_add_u32 m0, s49, 65536
    s_add_u32 s46, s47, 0
    buffer_load_dwordx4 v4, s[20:23], s46 offen lds
    s_add_u32 m0, s49, 66560
    s_add_u32 s46, s47, 8192
    buffer_load_dwordx4 v4, s[20:23], s46 offen lds
    s_add_u32 m0, s49, 67584
    s_add_u32 s46, s47, 16384
    buffer_load_dwordx4 v4, s[20:23], s46 offen lds
    s_add_u32 m0, s49, 68608
    s_add_u32 s46, s47, 24576
    buffer_load_dwordx4 v4, s[20:23], s46 offen lds
    s_add_u32 m0, s49, 69632
    s_add_u32 s46, s47, 32768
    buffer_load_dwordx4 v4, s[20:23], s46 offen lds
    s_add_u32 m0, s49, 70656
    s_add_u32 s46, s47, 40960
    buffer_load_dwordx4 v4, s[20:23], s46 offen lds
    s_add_u32 m0, s49, 71680
    s_add_u32 s46, s47, 49152
    buffer_load_dwordx4 v4, s[20:23], s46 offen lds
    s_add_u32 m0, s49, 72704
    s_add_u32 s46, s47, 57344
    buffer_load_dwordx4 v4, s[20:23], s46 offen lds
    s_waitcnt vmcnt(16)
    s_barrier
    s_add_u32 s47, s58, 2
    s_and_b32 s47, s47, 7
    s_lshl_b32 s47, s47, 7
    s_add_u32 s47, s47, s43
    s_add_u32 m0, s44, 0
    s_add_u32 s46, s47, 0
    buffer_load_dwordx4 v2, s[16:19], s46 offen lds
    s_add_u32 m0, s44, 1024
    s_add_u32 s46, s47, 16384
    buffer_load_dwordx4 v3, s[16:19], s46 offen lds
    s_add_u32 m0, s44, 2048
    s_add_u32 s46, s47, 32768
    buffer_load_dwordx4 v2, s[16:19], s46 offen lds
    s_add_u32 m0, s44, 3072
    s_add_u32 s46, s47, 49152
    buffer_load_dwordx4 v3, s[16:19], s46 offen lds
    s_add_u32 m0, s44, 8192
    s_add_u32 s46, s47, 65536
    buffer_load_dwordx4 v2, s[16:19], s46 offen lds
    s_add_u32 m0, s44, 9216
    s_add_u32 s46, s47, 81920
    buffer_load_dwordx4 v3, s[16:19], s46 offen lds
    s_add_u32 m0, s44, 10240
    s_add_u32 s46, s47, 98304
    buffer_load_dwordx4 v2, s[16:19], s46 offen lds
    s_add_u32 m0, s44, 11264
    s_add_u32 s46, s47, 114688
    buffer_load_dwordx4 v3, s[16:19], s46 offen lds
    s_add_u32 m0, s44, 16384
    s_add_u32 s46, s47, 131072
    buffer_load_dwordx4 v2, s[16:19], s46 offen lds
    s_add_u32 m0, s44, 17408
    s_add_u32 s46, s47, 147456
    buffer_load_dwordx4 v3, s[16:19], s46 offen lds
    s_add_u32 m0, s44, 18432
    s_add_u32 s46, s47, 163840
    buffer_load_dwordx4 v2, s[16:19], s46 offen lds
    s_add_u32 m0, s44, 19456
    s_add_u32 s46, s47, 180224
    buffer_load_dwordx4 v3, s[16:19], s46 offen lds
    s_add_u32 m0, s44, 24576
    s_add_u32 s46, s47, 196608
    buffer_load_dwordx4 v2, s[16:19], s46 offen lds
    s_add_u32 m0, s44, 25600
    s_add_u32 s46, s47, 212992
    buffer_load_dwordx4 v3, s[16:19], s46 offen lds
    s_add_u32 m0, s44, 26624
    s_add_u32 s46, s47, 229376
    buffer_load_dwordx4 v2, s[16:19], s46 offen lds
    s_add_u32 m0, s44, 27648
    s_add_u32 s46, s47, 245760
    buffer_load_dwordx4 v3, s[16:19], s46 offen lds
    s_waitcnt vmcnt(0)
    s_barrier
    s_add_u32 s47, s58, 3
    s_and_b32 s47, s47, 7
    s_lshl_b32 s47, s47, 7
    s_add_u32 s47, s47, s43
    s_add_u32 m0, s44, 4096
    s_add_u32 s46, s47, 0
    buffer_load_dwordx4 v2, s[16:19], s46 offen lds
    s_add_u32 m0, s44, 5120
    s_add_u32 s46, s47, 16384
    buffer_load_dwordx4 v3, s[16:19], s46 offen lds
    s_add_u32 m0, s44, 6144
    s_add_u32 s46, s47, 32768
    buffer_load_dwordx4 v2, s[16:19], s46 offen lds
    s_add_u32 m0, s44, 7168
    s_add_u32 s46, s47, 49152
    buffer_load_dwordx4 v3, s[16:19], s46 offen lds
    s_add_u32 m0, s44, 12288
    s_add_u32 s46, s47, 65536
    buffer_load_dwordx4 v2, s[16:19], s46 offen lds
    s_add_u32 m0, s44, 13312
    s_add_u32 s46, s47, 81920
    buffer_load_dwordx4 v3, s[16:19], s46 offen lds
    s_add_u32 m0, s44, 14336
    s_add_u32 s46, s47, 98304
    buffer_load_dwordx4 v2, s[16:19], s46 offen lds
    s_add_u32 m0, s44, 15360
    s_add_u32 s46, s47, 114688
    buffer_load_dwordx4 v3, s[16:19], s46 offen lds
    s_add_u32 m0, s44, 20480
    s_add_u32 s46, s47, 131072
    buffer_load_dwordx4 v2, s[16:19], s46 offen lds
    s_add_u32 m0, s44, 21504
    s_add_u32 s46, s47, 147456
    buffer_load_dwordx4 v3, s[16:19], s46 offen lds
    s_add_u32 m0, s44, 22528
    s_add_u32 s46, s47, 163840
    buffer_load_dwordx4 v2, s[16:19], s46 offen lds
    s_add_u32 m0, s44, 23552
    s_add_u32 s46, s47, 180224
    buffer_load_dwordx4 v3, s[16:19], s46 offen lds
    s_add_u32 m0, s44, 28672
    s_add_u32 s46, s47, 196608
    buffer_load_dwordx4 v2, s[16:19], s46 offen lds
    s_add_u32 m0, s44, 29696
    s_add_u32 s46, s47, 212992
    buffer_load_dwordx4 v3, s[16:19], s46 offen lds
    s_add_u32 m0, s44, 30720
    s_add_u32 s46, s47, 229376
    buffer_load_dwordx4 v2, s[16:19], s46 offen lds
    s_add_u32 m0, s44, 31744
    s_add_u32 s46, s47, 245760
    buffer_load_dwordx4 v3, s[16:19], s46 offen lds
    s_add_u32 s47, s58, 3
    s_and_b32 s47, s47, 7
    s_lshl_b32 s47, s47, 17
    s_add_u32 s47, s47, s45
    s_add_u32 m0, s49, 0
    s_add_u32 s46, s47, 0
    buffer_load_dwordx4 v4, s[20:23], s46 offen lds
    s_add_u32 m0, s49, 1024
    s_add_u32 s46, s47, 8192
    buffer_load_dwordx4 v4, s[20:23], s46 offen lds
    s_add_u32 m0, s49, 2048
    s_add_u32 s46, s47, 16384
    buffer_load_dwordx4 v4, s[20:23], s46 offen lds
    s_add_u32 m0, s49, 3072
    s_add_u32 s46, s47, 24576
    buffer_load_dwordx4 v4, s[20:23], s46 offen lds
    s_add_u32 m0, s49, 4096
    s_add_u32 s46, s47, 32768
    buffer_load_dwordx4 v4, s[20:23], s46 offen lds
    s_add_u32 m0, s49, 5120
    s_add_u32 s46, s47, 40960
    buffer_load_dwordx4 v4, s[20:23], s46 offen lds
    s_add_u32 m0, s49, 6144
    s_add_u32 s46, s47, 49152
    buffer_load_dwordx4 v4, s[20:23], s46 offen lds
    s_add_u32 m0, s49, 7168
    s_add_u32 s46, s47, 57344
    buffer_load_dwordx4 v4, s[20:23], s46 offen lds
    s_waitcnt vmcnt(8)
    s_barrier
    s_add_u32 s47, s58, 4
    s_and_b32 s47, s47, 7
    s_lshl_b32 s47, s47, 7
    s_add_u32 s47, s47, s43
    s_add_u32 m0, s44, 0
    s_add_u32 s46, s47, 0
    buffer_load_dwordx4 v2, s[16:19], s46 offen lds
    s_add_u32 m0, s44, 1024
    s_add_u32 s46, s47, 16384
    buffer_load_dwordx4 v3, s[16:19], s46 offen lds
    s_add_u32 m0, s44, 2048
    s_add_u32 s46, s47, 32768
    buffer_load_dwordx4 v2, s[16:19], s46 offen lds
    s_add_u32 m0, s44, 3072
    s_add_u32 s46, s47, 49152
    buffer_load_dwordx4 v3, s[16:19], s46 offen lds
    s_add_u32 m0, s44, 8192
    s_add_u32 s46, s47, 65536
    buffer_load_dwordx4 v2, s[16:19], s46 offen lds
    s_add_u32 m0, s44, 9216
    s_add_u32 s46, s47, 81920
    buffer_load_dwordx4 v3, s[16:19], s46 offen lds
    s_add_u32 m0, s44, 10240
    s_add_u32 s46, s47, 98304
    buffer_load_dwordx4 v2, s[16:19], s46 offen lds
    s_add_u32 m0, s44, 11264
    s_add_u32 s46, s47, 114688
    buffer_load_dwordx4 v3, s[16:19], s46 offen lds
    s_add_u32 m0, s44, 16384
    s_add_u32 s46, s47, 131072
    buffer_load_dwordx4 v2, s[16:19], s46 offen lds
    s_add_u32 m0, s44, 17408
    s_add_u32 s46, s47, 147456
    buffer_load_dwordx4 v3, s[16:19], s46 offen lds
    s_add_u32 m0, s44, 18432
    s_add_u32 s46, s47, 163840
    buffer_load_dwordx4 v2, s[16:19], s46 offen lds
    s_add_u32 m0, s44, 19456
    s_add_u32 s46, s47, 180224
    buffer_load_dwordx4 v3, s[16:19], s46 offen lds
    s_add_u32 m0, s44, 24576
    s_add_u32 s46, s47, 196608
    buffer_load_dwordx4 v2, s[16:19], s46 offen lds
    s_add_u32 m0, s44, 25600
    s_add_u32 s46, s47, 212992
    buffer_load_dwordx4 v3, s[16:19], s46 offen lds
    s_add_u32 m0, s44, 26624
    s_add_u32 s46, s47, 229376
    buffer_load_dwordx4 v2, s[16:19], s46 offen lds
    s_add_u32 m0, s44, 27648
    s_add_u32 s46, s47, 245760
    buffer_load_dwordx4 v3, s[16:19], s46 offen lds
    s_add_u32 s47, s58, 4
    s_and_b32 s47, s47, 7
    s_lshl_b32 s47, s47, 17
    s_add_u32 s47, s47, s45
    s_add_u32 m0, s49, 32768
    s_add_u32 s46, s47, 0
    buffer_load_dwordx4 v4, s[20:23], s46 offen lds
    s_add_u32 m0, s49, 33792
    s_add_u32 s46, s47, 8192
    buffer_load_dwordx4 v4, s[20:23], s46 offen lds
    s_add_u32 m0, s49, 34816
    s_add_u32 s46, s47, 16384
    buffer_load_dwordx4 v4, s[20:23], s46 offen lds
    s_add_u32 m0, s49, 35840
    s_add_u32 s46, s47, 24576
    buffer_load_dwordx4 v4, s[20:23], s46 offen lds
    s_add_u32 m0, s49, 36864
    s_add_u32 s46, s47, 32768
    buffer_load_dwordx4 v4, s[20:23], s46 offen lds
    s_add_u32 m0, s49, 37888
    s_add_u32 s46, s47, 40960
    buffer_load_dwordx4 v4, s[20:23], s46 offen lds
    s_add_u32 m0, s49, 38912
    s_add_u32 s46, s47, 49152
    buffer_load_dwordx4 v4, s[20:23], s46 offen lds
    s_add_u32 m0, s49, 39936
    s_add_u32 s46, s47, 57344
    buffer_load_dwordx4 v4, s[20:23], s46 offen lds
    s_waitcnt vmcnt(8)
    s_barrier
    s_add_u32 s47, s58, 5
    s_and_b32 s47, s47, 7
    s_lshl_b32 s47, s47, 7
    s_add_u32 s47, s47, s43
    s_add_u32 m0, s44, 4096
    s_add_u32 s46, s47, 0
    buffer_load_dwordx4 v2, s[16:19], s46 offen lds
    s_add_u32 m0, s44, 5120
    s_add_u32 s46, s47, 16384
    buffer_load_dwordx4 v3, s[16:19], s46 offen lds
    s_add_u32 m0, s44, 6144
    s_add_u32 s46, s47, 32768
    buffer_load_dwordx4 v2, s[16:19], s46 offen lds
    s_add_u32 m0, s44, 7168
    s_add_u32 s46, s47, 49152
    buffer_load_dwordx4 v3, s[16:19], s46 offen lds
    s_add_u32 m0, s44, 12288
    s_add_u32 s46, s47, 65536
    buffer_load_dwordx4 v2, s[16:19], s46 offen lds
    s_add_u32 m0, s44, 13312
    s_add_u32 s46, s47, 81920
    buffer_load_dwordx4 v3, s[16:19], s46 offen lds
    s_add_u32 m0, s44, 14336
    s_add_u32 s46, s47, 98304
    buffer_load_dwordx4 v2, s[16:19], s46 offen lds
    s_add_u32 m0, s44, 15360
    s_add_u32 s46, s47, 114688
    buffer_load_dwordx4 v3, s[16:19], s46 offen lds
    s_add_u32 m0, s44, 20480
    s_add_u32 s46, s47, 131072
    buffer_load_dwordx4 v2, s[16:19], s46 offen lds
    s_add_u32 m0, s44, 21504
    s_add_u32 s46, s47, 147456
    buffer_load_dwordx4 v3, s[16:19], s46 offen lds
    s_add_u32 m0, s44, 22528
    s_add_u32 s46, s47, 163840
    buffer_load_dwordx4 v2, s[16:19], s46 offen lds
    s_add_u32 m0, s44, 23552
    s_add_u32 s46, s47, 180224
    buffer_load_dwordx4 v3, s[16:19], s46 offen lds
    s_add_u32 m0, s44, 28672
    s_add_u32 s46, s47, 196608
    buffer_load_dwordx4 v2, s[16:19], s46 offen lds
    s_add_u32 m0, s44, 29696
    s_add_u32 s46, s47, 212992
    buffer_load_dwordx4 v3, s[16:19], s46 offen lds
    s_add_u32 m0, s44, 30720
    s_add_u32 s46, s47, 229376
    buffer_load_dwordx4 v2, s[16:19], s46 offen lds
    s_add_u32 m0, s44, 31744
    s_add_u32 s46, s47, 245760
    buffer_load_dwordx4 v3, s[16:19], s46 offen lds
    s_add_u32 s47, s58, 5
    s_and_b32 s47, s47, 7
    s_lshl_b32 s47, s47, 17
    s_add_u32 s47, s47, s45
    s_add_u32 m0, s49, 65536
    s_add_u32 s46, s47, 0
    buffer_load_dwordx4 v4, s[20:23], s46 offen lds
    s_add_u32 m0, s49, 66560
    s_add_u32 s46, s47, 8192
    buffer_load_dwordx4 v4, s[20:23], s46 offen lds
    s_add_u32 m0, s49, 67584
    s_add_u32 s46, s47, 16384
    buffer_load_dwordx4 v4, s[20:23], s46 offen lds
    s_add_u32 m0, s49, 68608
    s_add_u32 s46, s47, 24576
    buffer_load_dwordx4 v4, s[20:23], s46 offen lds
    s_add_u32 m0, s49, 69632
    s_add_u32 s46, s47, 32768
    buffer_load_dwordx4 v4, s[20:23], s46 offen lds
    s_add_u32 m0, s49, 70656
    s_add_u32 s46, s47, 40960
    buffer_load_dwordx4 v4, s[20:23], s46 offen lds
    s_add_u32 m0, s49, 71680
    s_add_u32 s46, s47, 49152
    buffer_load_dwordx4 v4, s[20:23], s46 offen lds
    s_add_u32 m0, s49, 72704
    s_add_u32 s46, s47, 57344
    buffer_load_dwordx4 v4, s[20:23], s46 offen lds
    s_waitcnt vmcnt(8)
    s_barrier
    s_add_u32 s47, s58, 6
    s_and_b32 s47, s47, 7
    s_lshl_b32 s47, s47, 7
    s_add_u32 s47, s47, s43
    s_add_u32 m0, s44, 0
    s_add_u32 s46, s47, 0
    buffer_load_dwordx4 v2, s[16:19], s46 offen lds
    s_add_u32 m0, s44, 1024
    s_add_u32 s46, s47, 16384
    buffer_load_dwordx4 v3, s[16:19], s46 offen lds
    s_add_u32 m0, s44, 2048
    s_add_u32 s46, s47, 32768
    buffer_load_dwordx4 v2, s[16:19], s46 offen lds
    s_add_u32 m0, s44, 3072
    s_add_u32 s46, s47, 49152
    buffer_load_dwordx4 v3, s[16:19], s46 offen lds
    s_add_u32 m0, s44, 8192
    s_add_u32 s46, s47, 65536
    buffer_load_dwordx4 v2, s[16:19], s46 offen lds
    s_add_u32 m0, s44, 9216
    s_add_u32 s46, s47, 81920
    buffer_load_dwordx4 v3, s[16:19], s46 offen lds
    s_add_u32 m0, s44, 10240
    s_add_u32 s46, s47, 98304
    buffer_load_dwordx4 v2, s[16:19], s46 offen lds
    s_add_u32 m0, s44, 11264
    s_add_u32 s46, s47, 114688
    buffer_load_dwordx4 v3, s[16:19], s46 offen lds
    s_add_u32 m0, s44, 16384
    s_add_u32 s46, s47, 131072
    buffer_load_dwordx4 v2, s[16:19], s46 offen lds
    s_add_u32 m0, s44, 17408
    s_add_u32 s46, s47, 147456
    buffer_load_dwordx4 v3, s[16:19], s46 offen lds
    s_add_u32 m0, s44, 18432
    s_add_u32 s46, s47, 163840
    buffer_load_dwordx4 v2, s[16:19], s46 offen lds
    s_add_u32 m0, s44, 19456
    s_add_u32 s46, s47, 180224
    buffer_load_dwordx4 v3, s[16:19], s46 offen lds
    s_add_u32 m0, s44, 24576
    s_add_u32 s46, s47, 196608
    buffer_load_dwordx4 v2, s[16:19], s46 offen lds
    s_add_u32 m0, s44, 25600
    s_add_u32 s46, s47, 212992
    buffer_load_dwordx4 v3, s[16:19], s46 offen lds
    s_add_u32 m0, s44, 26624
    s_add_u32 s46, s47, 229376
    buffer_load_dwordx4 v2, s[16:19], s46 offen lds
    s_add_u32 m0, s44, 27648
    s_add_u32 s46, s47, 245760
    buffer_load_dwordx4 v3, s[16:19], s46 offen lds
    s_add_u32 s47, s58, 6
    s_and_b32 s47, s47, 7
    s_lshl_b32 s47, s47, 17
    s_add_u32 s47, s47, s45
    s_add_u32 m0, s49, 0
    s_add_u32 s46, s47, 0
    buffer_load_dwordx4 v4, s[20:23], s46 offen lds
    s_add_u32 m0, s49, 1024
    s_add_u32 s46, s47, 8192
    buffer_load_dwordx4 v4, s[20:23], s46 offen lds
    s_add_u32 m0, s49, 2048
    s_add_u32 s46, s47, 16384
    buffer_load_dwordx4 v4, s[20:23], s46 offen lds
    s_add_u32 m0, s49, 3072
    s_add_u32 s46, s47, 24576
    buffer_load_dwordx4 v4, s[20:23], s46 offen lds
    s_add_u32 m0, s49, 4096
    s_add_u32 s46, s47, 32768
    buffer_load_dwordx4 v4, s[20:23], s46 offen lds
    s_add_u32 m0, s49, 5120
    s_add_u32 s46, s47, 40960
    buffer_load_dwordx4 v4, s[20:23], s46 offen lds
    s_add_u32 m0, s49, 6144
    s_add_u32 s46, s47, 49152
    buffer_load_dwordx4 v4, s[20:23], s46 offen lds
    s_add_u32 m0, s49, 7168
    s_add_u32 s46, s47, 57344
    buffer_load_dwordx4 v4, s[20:23], s46 offen lds
    s_waitcnt vmcnt(8)
    s_barrier
    s_add_u32 s47, s58, 7
    s_and_b32 s47, s47, 7
    s_lshl_b32 s47, s47, 7
    s_add_u32 s47, s47, s43
    s_add_u32 m0, s44, 4096
    s_add_u32 s46, s47, 0
    buffer_load_dwordx4 v2, s[16:19], s46 offen lds
    s_add_u32 m0, s44, 5120
    s_add_u32 s46, s47, 16384
    buffer_load_dwordx4 v3, s[16:19], s46 offen lds
    s_add_u32 m0, s44, 6144
    s_add_u32 s46, s47, 32768
    buffer_load_dwordx4 v2, s[16:19], s46 offen lds
    s_add_u32 m0, s44, 7168
    s_add_u32 s46, s47, 49152
    buffer_load_dwordx4 v3, s[16:19], s46 offen lds
    s_add_u32 m0, s44, 12288
    s_add_u32 s46, s47, 65536
    buffer_load_dwordx4 v2, s[16:19], s46 offen lds
    s_add_u32 m0, s44, 13312
    s_add_u32 s46, s47, 81920
    buffer_load_dwordx4 v3, s[16:19], s46 offen lds
    s_add_u32 m0, s44, 14336
    s_add_u32 s46, s47, 98304
    buffer_load_dwordx4 v2, s[16:19], s46 offen lds
    s_add_u32 m0, s44, 15360
    s_add_u32 s46, s47, 114688
    buffer_load_dwordx4 v3, s[16:19], s46 offen lds
    s_add_u32 m0, s44, 20480
    s_add_u32 s46, s47, 131072
    buffer_load_dwordx4 v2, s[16:19], s46 offen lds
    s_add_u32 m0, s44, 21504
    s_add_u32 s46, s47, 147456
    buffer_load_dwordx4 v3, s[16:19], s46 offen lds
    s_add_u32 m0, s44, 22528
    s_add_u32 s46, s47, 163840
    buffer_load_dwordx4 v2, s[16:19], s46 offen lds
    s_add_u32 m0, s44, 23552
    s_add_u32 s46, s47, 180224
    buffer_load_dwordx4 v3, s[16:19], s46 offen lds
    s_add_u32 m0, s44, 28672
    s_add_u32 s46, s47, 196608
    buffer_load_dwordx4 v2, s[16:19], s46 offen lds
    s_add_u32 m0, s44, 29696
    s_add_u32 s46, s47, 212992
    buffer_load_dwordx4 v3, s[16:19], s46 offen lds
    s_add_u32 m0, s44, 30720
    s_add_u32 s46, s47, 229376
    buffer_load_dwordx4 v2, s[16:19], s46 offen lds
    s_add_u32 m0, s44, 31744
    s_add_u32 s46, s47, 245760
    buffer_load_dwordx4 v3, s[16:19], s46 offen lds
    s_add_u32 s47, s58, 7
    s_and_b32 s47, s47, 7
    s_lshl_b32 s47, s47, 17
    s_add_u32 s47, s47, s45
    s_add_u32 m0, s49, 32768
    s_add_u32 s46, s47, 0
    buffer_load_dwordx4 v4, s[20:23], s46 offen lds
    s_add_u32 m0, s49, 33792
    s_add_u32 s46, s47, 8192
    buffer_load_dwordx4 v4, s[20:23], s46 offen lds
    s_add_u32 m0, s49, 34816
    s_add_u32 s46, s47, 16384
    buffer_load_dwordx4 v4, s[20:23], s46 offen lds
    s_add_u32 m0, s49, 35840
    s_add_u32 s46, s47, 24576
    buffer_load_dwordx4 v4, s[20:23], s46 offen lds
    s_add_u32 m0, s49, 36864
    s_add_u32 s46, s47, 32768
    buffer_load_dwordx4 v4, s[20:23], s46 offen lds
    s_add_u32 m0, s49, 37888
    s_add_u32 s46, s47, 40960
    buffer_load_dwordx4 v4, s[20:23], s46 offen lds
    s_add_u32 m0, s49, 38912
    s_add_u32 s46, s47, 49152
    buffer_load_dwordx4 v4, s[20:23], s46 offen lds
    s_add_u32 m0, s49, 39936
    s_add_u32 s46, s47, 57344
    buffer_load_dwordx4 v4, s[20:23], s46 offen lds
    s_mov_b32 s32, s56
    s_and_b32 s33, s57, 0xffff
    s_mov_b32 s34, 2097152
    s_mov_b32 s35, 0x00020000
    s_mov_b32 s60, s14
    s_and_b32 s61, s15, 0xffff
    s_mov_b32 s62, 256
    s_mov_b32 s63, 0x00020000
    s_sub_u32 s40, s39, 8
    s_lshl_b32 s46, s36, 3
    v_add_u32 v5, s46, v1
    s_mov_b64 s[50:51], 0xff
    s_lshl_b32 s64, s36, 14
    s_cmp_eq_u32 s40, 0
    s_cbranch_scc1 L_ts3848
    s_sub_u32 s41, s40, 1
    s_lshl_b32 s46, s41, 4
    v_add_u32 v5, s46, v1
    v_lshl_add_u32 v5, v5, 3, s37
    s_mov_b64 s[50:51], 0xffff
    s_lshl_b32 s64, s37, 15
    s_lshl_b32 s46, s41, 14
    s_add_u32 s64, s64, s46
    s_add_u32 s64, s64, 1048576
L_ts3848:
    v_lshlrev_b32 v5, 7, v5
    v_add_u32 v5, 1572864, v5
    v_mov_b32 v95, 0
    buffer_load_dword v7, v95, s[60:63], 0 offen sc0 sc1
    s_mov_b64 exec, s[50:51]
    buffer_load_dword v6, v5, s[32:35], 0 offen sc0 sc1
    s_mov_b64 exec, -1
    s_waitcnt vmcnt(10)
    s_barrier
    s_branch L_tail
L_load2:
    s_add_u32 s47, s58, 0
    s_and_b32 s47, s47, 7
    s_lshl_b32 s47, s47, 17
    s_add_u32 s47, s47, s45
    s_mov_b32 m0, 8192
    s_add_u32 s46, s47, 65536
    buffer_load_dwordx4 v4, s[20:23], s46 offen lds
    s_mov_b32 m0, 9216
    s_add_u32 s46, s47, 73728
    buffer_load_dwordx4 v4, s[20:23], s46 offen lds
    s_mov_b32 m0, 10240
    s_add_u32 s46, s47, 81920
    buffer_load_dwordx4 v4, s[20:23], s46 offen lds
    s_mov_b32 m0, 11264
    s_add_u32 s46, s47, 90112
    buffer_load_dwordx4 v4, s[20:23], s46 offen lds
    s_mov_b32 m0, 12288
    s_add_u32 s46, s47, 98304
    buffer_load_dwordx4 v4, s[20:23], s46 offen lds
    s_mov_b32 m0, 13312
    s_add_u32 s46, s47, 106496
    buffer_load_dwordx4 v4, s[20:23], s46 offen lds
    s_mov_b32 m0, 14336
    s_add_u32 s46, s47, 114688
    buffer_load_dwordx4 v4, s[20:23], s46 offen lds
    s_mov_b32 m0, 15360
    s_add_u32 s46, s47, 122880
    buffer_load_dwordx4 v4, s[20:23], s46 offen lds
    s_mov_b32 m0, 24576
    s_add_u32 s46, s47, 1114112
    buffer_load_dwordx4 v4, s[20:23], s46 offen lds
    s_mov_b32 m0, 25600
    s_add_u32 s46, s47, 1122304
    buffer_load_dwordx4 v4, s[20:23], s46 offen lds
    s_mov_b32 m0, 26624
    s_add_u32 s46, s47, 1130496
    buffer_load_dwordx4 v4, s[20:23], s46 offen lds
    s_mov_b32 m0, 27648
    s_add_u32 s46, s47, 1138688
    buffer_load_dwordx4 v4, s[20:23], s46 offen lds
    s_mov_b32 m0, 28672
    s_add_u32 s46, s47, 1146880
    buffer_load_dwordx4 v4, s[20:23], s46 offen lds
    s_mov_b32 m0, 29696
    s_add_u32 s46, s47, 1155072
    buffer_load_dwordx4 v4, s[20:23], s46 offen lds
    s_mov_b32 m0, 30720
    s_add_u32 s46, s47, 1163264
    buffer_load_dwordx4 v4, s[20:23], s46 offen lds
    s_mov_b32 m0, 31744
    s_add_u32 s46, s47, 1171456
    buffer_load_dwordx4 v4, s[20:23], s46 offen lds
    s_barrier
    s_add_u32 s47, s58, 1
    s_and_b32 s47, s47, 7
    s_lshl_b32 s47, s47, 17
    s_add_u32 s47, s47, s45
    s_mov_b32 m0, 40960
    s_add_u32 s46, s47, 65536
    buffer_load_dwordx4 v4, s[20:23], s46 offen lds
    s_mov_b32 m0, 41984
    s_add_u32 s46, s47, 73728
    buffer_load_dwordx4 v4, s[20:23], s46 offen lds
    s_mov_b32 m0, 43008
    s_add_u32 s46, s47, 81920
    buffer_load_dwordx4 v4, s[20:23], s46 offen lds
    s_mov_b32 m0, 44032
    s_add_u32 s46, s47, 90112
    buffer_load_dwordx4 v4, s[20:23], s46 offen lds
    s_mov_b32 m0, 45056
    s_add_u32 s46, s47, 98304
    buffer_load_dwordx4 v4, s[20:23], s46 offen lds
    s_mov_b32 m0, 46080
    s_add_u32 s46, s47, 106496
    buffer_load_dwordx4 v4, s[20:23], s46 offen lds
    s_mov_b32 m0, 47104
    s_add_u32 s46, s47, 114688
    buffer_load_dwordx4 v4, s[20:23], s46 offen lds
    s_mov_b32 m0, 48128
    s_add_u32 s46, s47, 122880
    buffer_load_dwordx4 v4, s[20:23], s46 offen lds
    s_mov_b32 m0, 57344
    s_add_u32 s46, s47, 1114112
    buffer_load_dwordx4 v4, s[20:23], s46 offen lds
    s_mov_b32 m0, 58368
    s_add_u32 s46, s47, 1122304
    buffer_load_dwordx4 v4, s[20:23], s46 offen lds
    s_mov_b32 m0, 59392
    s_add_u32 s46, s47, 1130496
    buffer_load_dwordx4 v4, s[20:23], s46 offen lds
    s_mov_b32 m0, 60416
    s_add_u32 s46, s47, 1138688
    buffer_load_dwordx4 v4, s[20:23], s46 offen lds
    s_mov_b32 m0, 61440
    s_add_u32 s46, s47, 1146880
    buffer_load_dwordx4 v4, s[20:23], s46 offen lds
    s_mov_b32 m0, 62464
    s_add_u32 s46, s47, 1155072
    buffer_load_dwordx4 v4, s[20:23], s46 offen lds
    s_mov_b32 m0, 63488
    s_add_u32 s46, s47, 1163264
    buffer_load_dwordx4 v4, s[20:23], s46 offen lds
    s_mov_b32 m0, 64512
    s_add_u32 s46, s47, 1171456
    buffer_load_dwordx4 v4, s[20:23], s46 offen lds
    s_add_u32 s47, s58, 2
    s_and_b32 s47, s47, 7
    s_lshl_b32 s47, s47, 17
    s_add_u32 s47, s47, s45
    s_mov_b32 m0, 73728
    s_add_u32 s46, s47, 65536
    buffer_load_dwordx4 v4, s[20:23], s46 offen lds
    s_mov_b32 m0, 74752
    s_add_u32 s46, s47, 73728
    buffer_load_dwordx4 v4, s[20:23], s46 offen lds
    s_mov_b32 m0, 75776
    s_add_u32 s46, s47, 81920
    buffer_load_dwordx4 v4, s[20:23], s46 offen lds
    s_mov_b32 m0, 76800
    s_add_u32 s46, s47, 90112
    buffer_load_dwordx4 v4, s[20:23], s46 offen lds
    s_mov_b32 m0, 77824
    s_add_u32 s46, s47, 98304
    buffer_load_dwordx4 v4, s[20:23], s46 offen lds
    s_mov_b32 m0, 78848
    s_add_u32 s46, s47, 106496
    buffer_load_dwordx4 v4, s[20:23], s46 offen lds
    s_mov_b32 m0, 79872
    s_add_u32 s46, s47, 114688
    buffer_load_dwordx4 v4, s[20:23], s46 offen lds
    s_mov_b32 m0, 80896
    s_add_u32 s46, s47, 122880
    buffer_load_dwordx4 v4, s[20:23], s46 offen lds
    s_mov_b32 m0, 90112
    s_add_u32 s46, s47, 1114112
    buffer_load_dwordx4 v4, s[20:23], s46 offen lds
    s_mov_b32 m0, 91136
    s_add_u32 s46, s47, 1122304
    buffer_load_dwordx4 v4, s[20:23], s46 offen lds
    s_mov_b32 m0, 92160
    s_add_u32 s46, s47, 1130496
    buffer_load_dwordx4 v4, s[20:23], s46 offen lds
    s_mov_b32 m0, 93184
    s_add_u32 s46, s47, 1138688
    buffer_load_dwordx4 v4, s[20:23], s46 offen lds
    s_mov_b32 m0, 94208
    s_add_u32 s46, s47, 1146880
    buffer_load_dwordx4 v4, s[20:23], s46 offen lds
    s_mov_b32 m0, 95232
    s_add_u32 s46, s47, 1155072
    buffer_load_dwordx4 v4, s[20:23], s46 offen lds
    s_mov_b32 m0, 96256
    s_add_u32 s46, s47, 1163264
    buffer_load_dwordx4 v4, s[20:23], s46 offen lds
    s_mov_b32 m0, 97280
    s_add_u32 s46, s47, 1171456
    buffer_load_dwordx4 v4, s[20:23], s46 offen lds
    s_waitcnt vmcnt(32)
    s_barrier
    s_waitcnt vmcnt(16)
    s_barrier
    s_add_u32 s47, s58, 3
    s_and_b32 s47, s47, 7
    s_lshl_b32 s47, s47, 17
    s_add_u32 s47, s47, s45
    s_mov_b32 m0, 8192
    s_add_u32 s46, s47, 65536
    buffer_load_dwordx4 v4, s[20:23], s46 offen lds
    s_mov_b32 m0, 9216
    s_add_u32 s46, s47, 73728
    buffer_load_dwordx4 v4, s[20:23], s46 offen lds
    s_mov_b32 m0, 10240
    s_add_u32 s46, s47, 81920
    buffer_load_dwordx4 v4, s[20:23], s46 offen lds
    s_mov_b32 m0, 11264
    s_add_u32 s46, s47, 90112
    buffer_load_dwordx4 v4, s[20:23], s46 offen lds
    s_mov_b32 m0, 12288
    s_add_u32 s46, s47, 98304
    buffer_load_dwordx4 v4, s[20:23], s46 offen lds
    s_mov_b32 m0, 13312
    s_add_u32 s46, s47, 106496
    buffer_load_dwordx4 v4, s[20:23], s46 offen lds
    s_mov_b32 m0, 14336
    s_add_u32 s46, s47, 114688
    buffer_load_dwordx4 v4, s[20:23], s46 offen lds
    s_mov_b32 m0, 15360
    s_add_u32 s46, s47, 122880
    buffer_load_dwordx4 v4, s[20:23], s46 offen lds
    s_mov_b32 m0, 24576
    s_add_u32 s46, s47, 1114112
    buffer_load_dwordx4 v4, s[20:23], s46 offen lds
    s_mov_b32 m0, 25600
    s_add_u32 s46, s47, 1122304
    buffer_load_dwordx4 v4, s[20:23], s46 offen lds
    s_mov_b32 m0, 26624
    s_add_u32 s46, s47, 1130496
    buffer_load_dwordx4 v4, s[20:23], s46 offen lds
    s_mov_b32 m0, 27648
    s_add_u32 s46, s47, 1138688
    buffer_load_dwordx4 v4, s[20:23], s46 offen lds
    s_mov_b32 m0, 28672
    s_add_u32 s46, s47, 1146880
    buffer_load_dwordx4 v4, s[20:23], s46 offen lds
    s_mov_b32 m0, 29696
    s_add_u32 s46, s47, 1155072
    buffer_load_dwordx4 v4, s[20:23], s46 offen lds
    s_mov_b32 m0, 30720
    s_add_u32 s46, s47, 1163264
    buffer_load_dwordx4 v4, s[20:23], s46 offen lds
    s_mov_b32 m0, 31744
    s_add_u32 s46, s47, 1171456
    buffer_load_dwordx4 v4, s[20:23], s46 offen lds
    s_waitcnt vmcnt(16)
    s_barrier
    s_add_u32 s47, s58, 4
    s_and_b32 s47, s47, 7
    s_lshl_b32 s47, s47, 17
    s_add_u32 s47, s47, s45
    s_mov_b32 m0, 40960
    s_add_u32 s46, s47, 65536
    buffer_load_dwordx4 v4, s[20:23], s46 offen lds
    s_mov_b32 m0, 41984
    s_add_u32 s46, s47, 73728
    buffer_load_dwordx4 v4, s[20:23], s46 offen lds
    s_mov_b32 m0, 43008
    s_add_u32 s46, s47, 81920
    buffer_load_dwordx4 v4, s[20:23], s46 offen lds
    s_mov_b32 m0, 44032
    s_add_u32 s46, s47, 90112
    buffer_load_dwordx4 v4, s[20:23], s46 offen lds
    s_mov_b32 m0, 45056
    s_add_u32 s46, s47, 98304
    buffer_load_dwordx4 v4, s[20:23], s46 offen lds
    s_mov_b32 m0, 46080
    s_add_u32 s46, s47, 106496
    buffer_load_dwordx4 v4, s[20:23], s46 offen lds
    s_mov_b32 m0, 47104
    s_add_u32 s46, s47, 114688
    buffer_load_dwordx4 v4, s[20:23], s46 offen lds
    s_mov_b32 m0, 48128
    s_add_u32 s46, s47, 122880
    buffer_load_dwordx4 v4, s[20:23], s46 offen lds
    s_mov_b32 m0, 57344
    s_add_u32 s46, s47, 1114112
    buffer_load_dwordx4 v4, s[20:23], s46 offen lds
    s_mov_b32 m0, 58368
    s_add_u32 s46, s47, 1122304
    buffer_load_dwordx4 v4, s[20:23], s46 offen lds
    s_mov_b32 m0, 59392
    s_add_u32 s46, s47, 1130496
    buffer_load_dwordx4 v4, s[20:23], s46 offen lds
    s_mov_b32 m0, 60416
    s_add_u32 s46, s47, 1138688
    buffer_load_dwordx4 v4, s[20:23], s46 offen lds
    s_mov_b32 m0, 61440
    s_add_u32 s46, s47, 1146880
    buffer_load_dwordx4 v4, s[20:23], s46 offen lds
    s_mov_b32 m0, 62464
    s_add_u32 s46, s47, 1155072
    buffer_load_dwordx4 v4, s[20:23], s46 offen lds
    s_mov_b32 m0, 63488
    s_add_u32 s46, s47, 1163264
    buffer_load_dwordx4 v4, s[20:23], s46 offen lds
    s_mov_b32 m0, 64512
    s_add_u32 s46, s47, 1171456
    buffer_load_dwordx4 v4, s[20:23], s46 offen lds
    s_waitcnt vmcnt(16)
    s_barrier
    s_add_u32 s47, s58, 5
    s_and_b32 s47, s47, 7
    s_lshl_b32 s47, s47, 17
    s_add_u32 s47, s47, s45
    s_mov_b32 m0, 73728
    s_add_u32 s46, s47, 65536
    buffer_load_dwordx4 v4, s[20:23], s46 offen lds
    s_mov_b32 m0, 74752
    s_add_u32 s46, s47, 73728
    buffer_load_dwordx4 v4, s[20:23], s46 offen lds
    s_mov_b32 m0, 75776
    s_add_u32 s46, s47, 81920
    buffer_load_dwordx4 v4, s[20:23], s46 offen lds
    s_mov_b32 m0, 76800
    s_add_u32 s46, s47, 90112
    buffer_load_dwordx4 v4, s[20:23], s46 offen lds
    s_mov_b32 m0, 77824
    s_add_u32 s46, s47, 98304
    buffer_load_dwordx4 v4, s[20:23], s46 offen lds
    s_mov_b32 m0, 78848
    s_add_u32 s46, s47, 106496
    buffer_load_dwordx4 v4, s[20:23], s46 offen lds
    s_mov_b32 m0, 79872
    s_add_u32 s46, s47, 114688
    buffer_load_dwordx4 v4, s[20:23], s46 offen lds
    s_mov_b32 m0, 80896
    s_add_u32 s46, s47, 122880
    buffer_load_dwordx4 v4, s[20:23], s46 offen lds
    s_mov_b32 m0, 90112
    s_add_u32 s46, s47, 1114112
    buffer_load_dwordx4 v4, s[20:23], s46 offen lds
    s_mov_b32 m0, 91136
    s_add_u32 s46, s47, 1122304
    buffer_load_dwordx4 v4, s[20:23], s46 offen lds
    s_mov_b32 m0, 92160
    s_add_u32 s46, s47, 1130496
    buffer_load_dwordx4 v4, s[20:23], s46 offen lds
    s_mov_b32 m0, 93184
    s_add_u32 s46, s47, 1138688
    buffer_load_dwordx4 v4, s[20:23], s46 offen lds
    s_mov_b32 m0, 94208
    s_add_u32 s46, s47, 1146880
    buffer_load_dwordx4 v4, s[20:23], s46 offen lds
    s_mov_b32 m0, 95232
    s_add_u32 s46, s47, 1155072
    buffer_load_dwordx4 v4, s[20:23], s46 offen lds
    s_mov_b32 m0, 96256
    s_add_u32 s46, s47, 1163264
    buffer_load_dwordx4 v4, s[20:23], s46 offen lds
    s_mov_b32 m0, 97280
    s_add_u32 s46, s47, 1171456
    buffer_load_dwordx4 v4, s[20:23], s46 offen lds
    s_waitcnt vmcnt(16)
    s_barrier
    s_add_u32 s47, s58, 6
    s_and_b32 s47, s47, 7
    s_lshl_b32 s47, s47, 17
    s_add_u32 s47, s47, s45
    s_mov_b32 m0, 8192
    s_add_u32 s46, s47, 65536
    buffer_load_dwordx4 v4, s[20:23], s46 offen lds
    s_mov_b32 m0, 9216
    s_add_u32 s46, s47, 73728
    buffer_load_dwordx4 v4, s[20:23], s46 offen lds
    s_mov_b32 m0, 10240
    s_add_u32 s46, s47, 81920
    buffer_load_dwordx4 v4, s[20:23], s46 offen lds
    s_mov_b32 m0, 11264
    s_add_u32 s46, s47, 90112
    buffer_load_dwordx4 v4, s[20:23], s46 offen lds
    s_mov_b32 m0, 12288
    s_add_u32 s46, s47, 98304
    buffer_load_dwordx4 v4, s[20:23], s46 offen lds
    s_mov_b32 m0, 13312
    s_add_u32 s46, s47, 106496
    buffer_load_dwordx4 v4, s[20:23], s46 offen lds
    s_mov_b32 m0, 14336
    s_add_u32 s46, s47, 114688
    buffer_load_dwordx4 v4, s[20:23], s46 offen lds
    s_mov_b32 m0, 15360
    s_add_u32 s46, s47, 122880
    buffer_load_dwordx4 v4, s[20:23], s46 offen lds
    s_mov_b32 m0, 24576
    s_add_u32 s46, s47, 1114112
    buffer_load_dwordx4 v4, s[20:23], s46 offen lds
    s_mov_b32 m0, 25600
    s_add_u32 s46, s47, 1122304
    buffer_load_dwordx4 v4, s[20:23], s46 offen lds
    s_mov_b32 m0, 26624
    s_add_u32 s46, s47, 1130496
    buffer_load_dwordx4 v4, s[20:23], s46 offen lds
    s_mov_b32 m0, 27648
    s_add_u32 s46, s47, 1138688
    buffer_load_dwordx4 v4, s[20:23], s46 offen lds
    s_mov_b32 m0, 28672
    s_add_u32 s46, s47, 1146880
    buffer_load_dwordx4 v4, s[20:23], s46 offen lds
    s_mov_b32 m0, 29696
    s_add_u32 s46, s47, 1155072
    buffer_load_dwordx4 v4, s[20:23], s46 offen lds
    s_mov_b32 m0, 30720
    s_add_u32 s46, s47, 1163264
    buffer_load_dwordx4 v4, s[20:23], s46 offen lds
    s_mov_b32 m0, 31744
    s_add_u32 s46, s47, 1171456
    buffer_load_dwordx4 v4, s[20:23], s46 offen lds
    s_waitcnt vmcnt(16)
    s_barrier
    s_add_u32 s47, s58, 7
    s_and_b32 s47, s47, 7
    s_lshl_b32 s47, s47, 17
    s_add_u32 s47, s47, s45
    s_mov_b32 m0, 40960
    s_add_u32 s46, s47, 65536
    buffer_load_dwordx4 v4, s[20:23], s46 offen lds
    s_mov_b32 m0, 41984
    s_add_u32 s46, s47, 73728
    buffer_load_dwordx4 v4, s[20:23], s46 offen lds
    s_mov_b32 m0, 43008
    s_add_u32 s46, s47, 81920
    buffer_load_dwordx4 v4, s[20:23], s46 offen lds
    s_mov_b32 m0, 44032
    s_add_u32 s46, s47, 90112
    buffer_load_dwordx4 v4, s[20:23], s46 offen lds
    s_mov_b32 m0, 45056
    s_add_u32 s46, s47, 98304
    buffer_load_dwordx4 v4, s[20:23], s46 offen lds
    s_mov_b32 m0, 46080
    s_add_u32 s46, s47, 106496
    buffer_load_dwordx4 v4, s[20:23], s46 offen lds
    s_mov_b32 m0, 47104
    s_add_u32 s46, s47, 114688
    buffer_load_dwordx4 v4, s[20:23], s46 offen lds
    s_mov_b32 m0, 48128
    s_add_u32 s46, s47, 122880
    buffer_load_dwordx4 v4, s[20:23], s46 offen lds
    s_mov_b32 m0, 57344
    s_add_u32 s46, s47, 1114112
    buffer_load_dwordx4 v4, s[20:23], s46 offen lds
    s_mov_b32 m0, 58368
    s_add_u32 s46, s47, 1122304
    buffer_load_dwordx4 v4, s[20:23], s46 offen lds
    s_mov_b32 m0, 59392
    s_add_u32 s46, s47, 1130496
    buffer_load_dwordx4 v4, s[20:23], s46 offen lds
    s_mov_b32 m0, 60416
    s_add_u32 s46, s47, 1138688
    buffer_load_dwordx4 v4, s[20:23], s46 offen lds
    s_mov_b32 m0, 61440
    s_add_u32 s46, s47, 1146880
    buffer_load_dwordx4 v4, s[20:23], s46 offen lds
    s_mov_b32 m0, 62464
    s_add_u32 s46, s47, 1155072
    buffer_load_dwordx4 v4, s[20:23], s46 offen lds
    s_mov_b32 m0, 63488
    s_add_u32 s46, s47, 1163264
    buffer_load_dwordx4 v4, s[20:23], s46 offen lds
    s_mov_b32 m0, 64512
    s_add_u32 s46, s47, 1171456
    buffer_load_dwordx4 v4, s[20:23], s46 offen lds
    s_mov_b32 s32, s56
    s_and_b32 s33, s57, 0xffff
    s_mov_b32 s34, 2097152
    s_mov_b32 s35, 0x00020000
    s_mov_b32 s60, s14
    s_and_b32 s61, s15, 0xffff
    s_mov_b32 s62, 256
    s_mov_b32 s63, 0x00020000
    s_sub_u32 s40, s39, 8
    s_lshl_b32 s46, s36, 3
    v_add_u32 v5, s46, v1
    s_mov_b64 s[50:51], 0xff
    s_lshl_b32 s64, s36, 14
    s_cmp_eq_u32 s40, 0
    s_cbranch_scc1 L_ts4313
    s_sub_u32 s41, s40, 1
    s_lshl_b32 s46, s41, 4
    v_add_u32 v5, s46, v1
    v_lshl_add_u32 v5, v5, 3, s37
    s_mov_b64 s[50:51], 0xffff
    s_lshl_b32 s64, s37, 15
    s_lshl_b32 s46, s41, 14
    s_add_u32 s64, s64, s46
    s_add_u32 s64, s64, 1048576
L_ts4313:
    v_lshlrev_b32 v5, 7, v5
    v_add_u32 v5, 1572864, v5
    v_mov_b32 v95, 0
    buffer_load_dword v7, v95, s[60:63], 0 offen sc0 sc1
    s_mov_b64 exec, s[50:51]
    buffer_load_dword v6, v5, s[32:35], 0 offen sc0 sc1
    s_mov_b64 exec, -1
    s_waitcnt vmcnt(18)
    s_barrier
    s_branch L_tail
L_aux:
    s_mov_b32 s24, s6
    s_and_b32 s25, s7, 0xffff
    s_mov_b32 s26, 2048
    s_mov_b32 s27, 0x00020000
    s_mov_b32 s28, s8
    s_and_b32 s29, s9, 0xffff
    s_mov_b32 s30, 2048
    s_mov_b32 s31, 0x00020000
    s_lshr_b32 s40, s42, 1
    s_and_b32 s41, s42, 1
    v_lshrrev_b32 v92, 5, v1
    v_lshlrev_b32 v48, 4, v92
    s_lshl_b32 s46, s40, 10
    s_lshl_b32 s47, s58, 7
    s_add_u32 s46, s46, s47
    s_lshl_b32 s47, s41, 6
    s_add_u32 s47, s46, s47
    s_mov_b32 s50, 0x55555555
    s_mov_b32 s51, 0x55555555
    s_mov_b64 exec, s[50:51]
    buffer_load_dwordx4 v[96:99], v48, s[24:27], s47 offen offset:0
    buffer_load_dwordx4 v[100:103], v48, s[24:27], s47 offen offset:32
    s_not_b64 exec, exec
    buffer_load_dwordx4 v[96:99], v48, s[28:31], s47 offen offset:0
    buffer_load_dwordx4 v[100:103], v48, s[28:31], s47 offen offset:32
    s_mov_b64 exec, -1
    s_mov_b32 s32, s56
    s_and_b32 s33, s57, 0xffff
    s_mov_b32 s34, 2097152
    s_mov_b32 s35, 0x00020000
    s_mov_b32 s60, s14
    s_and_b32 s61, s15, 0xffff
    s_mov_b32 s62, 256
    s_mov_b32 s63, 0x00020000
    v_mov_b32 v7, 0
    s_cmp_lg_u32 s2, 0
    s_cbranch_scc1 L_nononce
    s_memrealtime s[54:55]
    s_waitcnt lgkmcnt(0)
    s_or_b32 s54, s54, 1
    v_mov_b32 v6, s54
    s_mov_b64 exec, 1
    buffer_store_dword v6, v7, s[60:63], 0 offen sc0 sc1
    s_mov_b64 exec, -1
L_nononce:
    v_bfe_u32 v93, v1, 2, 2
    v_lshl_add_u32 v94, v92, 3, v93
    v_lshlrev_b32 v94, 8, v94
    v_bfe_u32 v95, v1, 4, 1
    v_lshl_add_u32 v94, v95, 5, v94
    v_and_b32 v95, 3, v1
    v_lshl_add_u32 v94, v95, 3, v94
    s_lshl_b32 s46, s40, 14
    s_lshl_b32 s47, s41, 13
    s_add_u32 s46, s46, s47
    v_add_u32 v94, s46, v94
    v_xor_b32 v95, 0, v93
    v_lshl_add_u32 v72, v95, 6, v94
    v_xor_b32 v95, 1, v93
    v_lshl_add_u32 v73, v95, 6, v94
    v_xor_b32 v95, 2, v93
    v_lshl_add_u32 v74, v95, 6, v94
    v_xor_b32 v95, 3, v93
    v_lshl_add_u32 v75, v95, 6, v94
    v_accvgpr_write_b32 a0, 0
    v_accvgpr_write_b32 a1, 0
    v_accvgpr_write_b32 a2, 0
    v_accvgpr_write_b32 a3, 0
    v_accvgpr_write_b32 a4, 0
    v_accvgpr_write_b32 a5, 0
    v_accvgpr_write_b32 a6, 0
    v_accvgpr_write_b32 a7, 0
    v_accvgpr_write_b32 a8, 0
    v_accvgpr_write_b32 a9, 0
    v_accvgpr_write_b32 a10, 0
    v_accvgpr_write_b32 a11, 0
    v_accvgpr_write_b32 a12, 0
    v_accvgpr_write_b32 a13, 0
    v_accvgpr_write_b32 a14, 0
    v_accvgpr_write_b32 a15, 0
    v_accvgpr_write_b32 a16, 0
    v_accvgpr_write_b32 a17, 0
    v_accvgpr_write_b32 a18, 0
    v_accvgpr_write_b32 a19, 0
    v_accvgpr_write_b32 a20, 0
    v_accvgpr_write_b32 a21, 0
    v_accvgpr_write_b32 a22, 0
    v_accvgpr_write_b32 a23, 0
    v_accvgpr_write_b32 a24, 0
    v_accvgpr_write_b32 a25, 0
    v_accvgpr_write_b32 a26, 0
    v_accvgpr_write_b32 a27, 0
    v_accvgpr_write_b32 a28, 0
    v_accvgpr_write_b32 a29, 0
    v_accvgpr_write_b32 a30, 0
    v_accvgpr_write_b32 a31, 0
    v_accvgpr_write_b32 a32, 0
    v_accvgpr_write_b32 a33, 0
    v_accvgpr_write_b32 a34, 0
    v_accvgpr_write_b32 a35, 0
    v_accvgpr_write_b32 a36, 0
    v_accvgpr_write_b32 a37, 0
    v_accvgpr_write_b32 a38, 0
    v_accvgpr_write_b32 a39, 0
    v_accvgpr_write_b32 a40, 0
    v_accvgpr_write_b32 a41, 0
    v_accvgpr_write_b32 a42, 0
    v_accvgpr_write_b32 a43, 0
    v_accvgpr_write_b32 a44, 0
    v_accvgpr_write_b32 a45, 0
    v_accvgpr_write_b32 a46, 0
    v_accvgpr_write_b32 a47, 0
    v_accvgpr_write_b32 a48, 0
    v_accvgpr_write_b32 a49, 0
    v_accvgpr_write_b32 a50, 0
    v_accvgpr_write_b32 a51, 0
    v_accvgpr_write_b32 a52, 0
    v_accvgpr_write_b32 a53, 0
    v_accvgpr_write_b32 a54, 0
    v_accvgpr_write_b32 a55, 0
    v_accvgpr_write_b32 a56, 0
    v_accvgpr_write_b32 a57, 0
    v_accvgpr_write_b32 a58, 0
    v_accvgpr_write_b32 a59, 0
    v_accvgpr_write_b32 a60, 0
    v_accvgpr_write_b32 a61, 0
    v_accvgpr_write_b32 a62, 0
    v_accvgpr_write_b32 a63, 0
    v_and_b32 v93, 31, v1
    v_lshlrev_b32 v94, 9, v93
    v_lshl_add_u32 v94, v92, 4, v94
    s_lshl_b32 s46, s37, 5
    s_lshl_b32 s47, s40, 4
    s_add_u32 s46, s46, s47
    s_lshl_b32 s47, s58, 1
    s_add_u32 s46, s46, s47
    s_add_u32 s46, s46, s41
    s_lshl_b32 s46, s46, 10
    s_add_u32 s59, s46, 1048576
    s_barrier
    s_barrier
    ds_read_b64_tr_b16 v[8:9], v72 offset:0
    ds_read_b64_tr_b16 v[10:11], v72 offset:1024
    ds_read_b64_tr_b16 v[12:13], v73 offset:0
    ds_read_b64_tr_b16 v[14:15], v73 offset:1024
    ds_read_b64_tr_b16 v[16:17], v74 offset:0
    ds_read_b64_tr_b16 v[18:19], v74 offset:1024
    ds_read_b64_tr_b16 v[20:21], v75 offset:0
    ds_read_b64_tr_b16 v[22:23], v75 offset:1024
    ds_read_b64_tr_b16 v[24:25], v72 offset:4096
    ds_read_b64_tr_b16 v[26:27], v72 offset:5120
    ds_read_b64_tr_b16 v[28:29], v73 offset:4096
    ds_read_b64_tr_b16 v[30:31], v73 offset:5120
    ds_read_b64_tr_b16 v[32:33], v74 offset:4096
    ds_read_b64_tr_b16 v[34:35], v74 offset:5120
    ds_read_b64_tr_b16 v[36:37], v75 offset:4096
    ds_read_b64_tr_b16 v[38:39], v75 offset:5120
    s_waitcnt vmcnt(0) lgkmcnt(0)
    v_mfma_f32_32x32x16_bf16 a[0:15], v[8:11], v[96:99], a[0:15]
    v_mfma_f32_32x32x16_bf16 a[16:31], v[12:15], v[96:99], a[16:31]
    v_mfma_f32_32x32x16_bf16 a[32:47], v[16:19], v[96:99], a[32:47]
    v_mfma_f32_32x32x16_bf16 a[48:63], v[20:23], v[96:99], a[48:63]
    v_mfma_f32_32x32x16_bf16 a[0:15], v[24:27], v[100:103], a[0:15]
    v_mfma_f32_32x32x16_bf16 a[16:31], v[28:31], v[100:103], a[16:31]
    v_mfma_f32_32x32x16_bf16 a[32:47], v[32:35], v[100:103], a[32:47]
    v_mfma_f32_32x32x16_bf16 a[48:63], v[36:39], v[100:103], a[48:63]
    s_nop 7
    s_nop 7
    v_cmp_gt_u32 vcc, 2, v93
    s_and_saveexec_b64 s[50:51], vcc
    buffer_store_dwordx4 a[0:3], v94, s[32:35], s59 offen offset:0 sc0 sc1
    buffer_store_dwordx4 a[4:7], v94, s[32:35], s59 offen offset:32 sc0 sc1
    buffer_store_dwordx4 a[8:11], v94, s[32:35], s59 offen offset:64 sc0 sc1
    buffer_store_dwordx4 a[12:15], v94, s[32:35], s59 offen offset:96 sc0 sc1
    buffer_store_dwordx4 a[16:19], v94, s[32:35], s59 offen offset:128 sc0 sc1
    buffer_store_dwordx4 a[20:23], v94, s[32:35], s59 offen offset:160 sc0 sc1
    buffer_store_dwordx4 a[24:27], v94, s[32:35], s59 offen offset:192 sc0 sc1
    buffer_store_dwordx4 a[28:31], v94, s[32:35], s59 offen offset:224 sc0 sc1
    buffer_store_dwordx4 a[32:35], v94, s[32:35], s59 offen offset:256 sc0 sc1
    buffer_store_dwordx4 a[36:39], v94, s[32:35], s59 offen offset:288 sc0 sc1
    buffer_store_dwordx4 a[40:43], v94, s[32:35], s59 offen offset:320 sc0 sc1
    buffer_store_dwordx4 a[44:47], v94, s[32:35], s59 offen offset:352 sc0 sc1
    buffer_store_dwordx4 a[48:51], v94, s[32:35], s59 offen offset:384 sc0 sc1
    buffer_store_dwordx4 a[52:55], v94, s[32:35], s59 offen offset:416 sc0 sc1
    buffer_store_dwordx4 a[56:59], v94, s[32:35], s59 offen offset:448 sc0 sc1
    buffer_store_dwordx4 a[60:63], v94, s[32:35], s59 offen offset:480 sc0 sc1
    s_mov_b64 exec, -1
    buffer_load_dword v6, v7, s[60:63], 0 offen sc0 sc1
    s_barrier
    s_barrier
    s_mov_b32 s52, 3000
L_nonce:
    s_waitcnt vmcnt(0)
    v_readfirstlane_b32 s54, v6
    s_cmp_lg_u32 s54, 0
    s_cbranch_scc1 L_gotnonce
    s_cmp_eq_u32 s52, 0
    s_cbranch_scc1 L_noflag
    s_sub_u32 s52, s52, 1
    buffer_load_dword v6, v7, s[60:63], 0 offen sc0 sc1
    s_branch L_nonce
L_gotnonce:
    s_lshl_b32 s46, s36, 3
    s_add_u32 s46, s46, s37
    s_lshl_b32 s46, s46, 7
    s_add_u32 s46, s46, 1572864
    v_mov_b32 v92, s46
    s_mov_b64 exec, 1
    buffer_store_dword v6, v92, s[32:35], 0 offen sc0 sc1
    s_mov_b64 exec, -1
L_noflag:
    s_barrier
    s_barrier
    s_barrier
    s_barrier
    s_barrier
    s_barrier
    s_endpgm
L_tail:
    s_mov_b32 s53, 1
    s_mov_b32 s52, 5000
L_poll:
    s_waitcnt vmcnt(0)
    v_readfirstlane_b32 s54, v7
    s_mov_b64 exec, s[50:51]
    v_cmp_ne_u32 vcc, v7, v6
    s_mov_b64 exec, -1
    s_cmp_eq_u32 s54, 0
    s_cbranch_scc1 L_retry
    s_cbranch_vccz L_gather
L_retry:
    s_cmp_eq_u32 s53, 0
    s_cbranch_scc1 L_t1
    s_sub_u32 s53, s53, 1
    s_barrier
L_t1:
    s_cmp_eq_u32 s52, 0
    s_cbranch_scc1 L_fallback
    s_sub_u32 s52, s52, 1
    buffer_load_dword v7, v95, s[60:63], 0 offen sc0 sc1
    s_mov_b64 exec, s[50:51]
    buffer_load_dword v6, v5, s[32:35], 0 offen sc0 sc1
    s_mov_b64 exec, -1
    s_branch L_poll
L_gather:
    v_lshlrev_b32 v92, 4, v1
    s_mov_b32 s46, s64
    buffer_load_dwordx4 v[24:27], v92, s[32:35], s46 offen offset:0 sc0 sc1
    buffer_load_dwordx4 v[28:31], v92, s[32:35], s46 offen offset:1024 sc0 sc1
    buffer_load_dwordx4 v[32:35], v92, s[32:35], s46 offen offset:2048 sc0 sc1
    buffer_load_dwordx4 v[36:39], v92, s[32:35], s46 offen offset:3072 sc0 sc1
    s_add_u32 s46, s46, 4096
    buffer_load_dwordx4 v[40:43], v92, s[32:35], s46 offen offset:0 sc0 sc1
    buffer_load_dwordx4 v[44:47], v92, s[32:35], s46 offen offset:1024 sc0 sc1
    buffer_load_dwordx4 v[48:51], v92, s[32:35], s46 offen offset:2048 sc0 sc1
    buffer_load_dwordx4 v[52:55], v92, s[32:35], s46 offen offset:3072 sc0 sc1
    s_add_u32 s46, s46, 4096
    buffer_load_dwordx4 v[56:59], v92, s[32:35], s46 offen offset:0 sc0 sc1
    buffer_load_dwordx4 v[60:63], v92, s[32:35], s46 offen offset:1024 sc0 sc1
    buffer_load_dwordx4 v[64:67], v92, s[32:35], s46 offen offset:2048 sc0 sc1
    buffer_load_dwordx4 v[68:71], v92, s[32:35], s46 offen offset:3072 sc0 sc1
    s_add_u32 s46, s46, 4096
    buffer_load_dwordx4 v[72:75], v92, s[32:35], s46 offen offset:0 sc0 sc1
    buffer_load_dwordx4 v[76:79], v92, s[32:35], s46 offen offset:1024 sc0 sc1
    buffer_load_dwordx4 v[80:83], v92, s[32:35], s46 offen offset:2048 sc0 sc1
    buffer_load_dwordx4 v[84:87], v92, s[32:35], s46 offen offset:3072 sc0 sc1
    s_cmp_eq_u32 s53, 0
    s_cbranch_scc1 L_t2
    s_sub_u32 s53, s53, 1
    s_barrier
L_t2:
    s_waitcnt vmcnt(0)
    v_add_f32 v16, v24, v28
    v_add_f32 v17, v25, v29
    v_add_f32 v18, v26, v30
    v_add_f32 v19, v27, v31
    v_add_f32 v16, v16, v32
    v_add_f32 v17, v17, v33
    v_add_f32 v18, v18, v34
    v_add_f32 v19, v19, v35
    v_add_f32 v16, v16, v36
    v_add_f32 v17, v17, v37
    v_add_f32 v18, v18, v38
    v_add_f32 v19, v19, v39
    v_add_f32 v16, v16, v40
    v_add_f32 v17, v17, v41
    v_add_f32 v18, v18, v42
    v_add_f32 v19, v19, v43
    v_add_f32 v16, v16, v44
    v_add_f32 v17, v17, v45
    v_add_f32 v18, v18, v46
    v_add_f32 v19, v19, v47
    v_add_f32 v16, v16, v48
    v_add_f32 v17, v17, v49
    v_add_f32 v18, v18, v50
    v_add_f32 v19, v19, v51
    v_add_f32 v16, v16, v52
    v_add_f32 v17, v17, v53
    v_add_f32 v18, v18, v54
    v_add_f32 v19, v19, v55
    v_add_f32 v16, v16, v56
    v_add_f32 v17, v17, v57
    v_add_f32 v18, v18, v58
    v_add_f32 v19, v19, v59
    v_add_f32 v16, v16, v60
    v_add_f32 v17, v17, v61
    v_add_f32 v18, v18, v62
    v_add_f32 v19, v19, v63
    v_add_f32 v16, v16, v64
    v_add_f32 v17, v17, v65
    v_add_f32 v18, v18, v66
    v_add_f32 v19, v19, v67
    v_add_f32 v16, v16, v68
    v_add_f32 v17, v17, v69
    v_add_f32 v18, v18, v70
    v_add_f32 v19, v19, v71
    v_add_f32 v16, v16, v72
    v_add_f32 v17, v17, v73
    v_add_f32 v18, v18, v74
    v_add_f32 v19, v19, v75
    v_add_f32 v16, v16, v76
    v_add_f32 v17, v17, v77
    v_add_f32 v18, v18, v78
    v_add_f32 v19, v19, v79
    v_add_f32 v16, v16, v80
    v_add_f32 v17, v17, v81
    v_add_f32 v18, v18, v82
    v_add_f32 v19, v19, v83
    v_add_f32 v16, v16, v84
    v_add_f32 v17, v17, v85
    v_add_f32 v18, v18, v86
    v_add_f32 v19, v19, v87
    s_cmp_lg_u32 s40, 0
    s_cbranch_scc1 L_wr_s
    v_mul_f32 v16, 0x3a800000, v16
    v_mul_f32 v17, 0x3a800000, v17
    v_fma_f32 v17, -v16, v16, v17
    v_max_f32 v17, 0, v17
    v_cvt_pk_bf16_f32 v11, v16, v17
    v_lshlrev_b32 v8, 16, v11
    v_and_b32 v17, 0xffff0000, v11
    v_add_f32 v17, 0x3727c5ac, v17
    v_cvt_pk_bf16_f32 v11, v17, v17
    v_lshlrev_b32 v17, 16, v11
    v_sqrt_f32 v17, v17
    s_nop 0
    v_cvt_pk_bf16_f32 v11, v17, v17
    v_lshlrev_b32 v9, 16, v11
    v_rcp_f32 v10, v9
    s_nop 0
    v_mul_f32 v18, 0x3a800000, v18
    v_mul_f32 v19, 0x3a800000, v19
    v_fma_f32 v19, -v18, v18, v19
    v_max_f32 v19, 0, v19
    v_cvt_pk_bf16_f32 v15, v18, v19
    v_lshlrev_b32 v12, 16, v15
    v_and_b32 v19, 0xffff0000, v15
    v_add_f32 v19, 0x3727c5ac, v19
    v_cvt_pk_bf16_f32 v15, v19, v19
    v_lshlrev_b32 v19, 16, v15
    v_sqrt_f32 v19, v19
    s_nop 0
    v_cvt_pk_bf16_f32 v15, v19, v19
    v_lshlrev_b32 v13, 16, v15
    v_rcp_f32 v14, v13
    s_nop 0
L_wr_row:
    v_lshlrev_b32 v93, 5, v1
    v_add_u32 v93, 98304, v93
    ds_write_b128 v93, v[8:11]
    ds_write_b128 v93, v[12:15] offset:16
    s_branch L_tdone
L_wr_s:
    v_lshrrev_b32 v94, 5, v1
    v_and_b32 v93, 31, v1
    v_lshlrev_b32 v93, 4, v93
    v_lshl_add_u32 v93, v94, 10, v93
    s_lshl_b32 s46, s41, 9
    s_add_u32 s46, s46, 100352
    v_add_u32 v93, s46, v93
    ds_write_b128 v93, v[16:19]
L_tdone:
    s_waitcnt lgkmcnt(0)
    s_barrier
    s_endpgm
L_fallback:
    s_mov_b32 s24, s6
    s_and_b32 s25, s7, 0xffff
    s_mov_b32 s26, 2048
    s_mov_b32 s27, 0x00020000
    s_mov_b32 s28, s8
    s_and_b32 s29, s9, 0xffff
    s_mov_b32 s30, 2048
    s_mov_b32 s31, 0x00020000
    s_cmp_lg_u32 s40, 0
    s_cbranch_scc1 L_fb_s
    s_mov_b32 s55, 0x3f803f80
    v_lshlrev_b32 v92, 12, v1
    s_lshl_b32 s46, s36, 18
    s_add_u32 s46, s46, 0
    v_mov_b32 v30, 0
    v_mov_b32 v31, 0
    s_mov_b32 s52, 128
L_fb1_0:
    buffer_load_dwordx4 v[24:27], v92, s[16:19], s46 offen
    s_waitcnt vmcnt(0)
    v_dot2_f32_bf16 v30, v24, s55, v30
    v_dot2_f32_bf16 v31, v24, v24, v31
    v_dot2_f32_bf16 v30, v25, s55, v30
    v_dot2_f32_bf16 v31, v25, v25, v31
    v_dot2_f32_bf16 v30, v26, s55, v30
    v_dot2_f32_bf16 v31, v26, v26, v31
    v_dot2_f32_bf16 v30, v27, s55, v30
    v_dot2_f32_bf16 v31, v27, v27, v31
    s_add_u32 s46, s46, 16
    s_sub_u32 s52, s52, 1
    s_cmp_lg_u32 s52, 0
    s_cbranch_scc1 L_fb1_0
    s_nop 2
    v_mul_f32 v30, 0x3a800000, v30
    v_mul_f32 v31, 0x3a800000, v31
    v_fma_f32 v31, -v30, v30, v31
    v_max_f32 v31, 0, v31
    v_cvt_pk_bf16_f32 v11, v30, v31
    v_lshlrev_b32 v8, 16, v11
    v_and_b32 v31, 0xffff0000, v11
    v_add_f32 v31, 0x3727c5ac, v31
    v_cvt_pk_bf16_f32 v11, v31, v31
    v_lshlrev_b32 v31, 16, v11
    v_sqrt_f32 v31, v31
    s_nop 0
    v_cvt_pk_bf16_f32 v11, v31, v31
    v_lshlrev_b32 v9, 16, v11
    v_rcp_f32 v10, v9
    s_nop 0
    v_lshlrev_b32 v92, 12, v1
    s_lshl_b32 s46, s36, 18
    s_add_u32 s46, s46, 2048
    v_mov_b32 v30, 0
    v_mov_b32 v31, 0
    s_mov_b32 s52, 128
L_fb1_1:
    buffer_load_dwordx4 v[24:27], v92, s[16:19], s46 offen
    s_waitcnt vmcnt(0)
    v_dot2_f32_bf16 v30, v24, s55, v30
    v_dot2_f32_bf16 v31, v24, v24, v31
    v_dot2_f32_bf16 v30, v25, s55, v30
    v_dot2_f32_bf16 v31, v25, v25, v31
    v_dot2_f32_bf16 v30, v26, s55, v30
    v_dot2_f32_bf16 v31, v26, v26, v31
    v_dot2_f32_bf16 v30, v27, s55, v30
    v_dot2_f32_bf16 v31, v27, v27, v31
    s_add_u32 s46, s46, 16
    s_sub_u32 s52, s52, 1
    s_cmp_lg_u32 s52, 0
    s_cbranch_scc1 L_fb1_1
    s_nop 2
    v_mul_f32 v30, 0x3a800000, v30
    v_mul_f32 v31, 0x3a800000, v31
    v_fma_f32 v31, -v30, v30, v31
    v_max_f32 v31, 0, v31
    v_cvt_pk_bf16_f32 v15, v30, v31
    v_lshlrev_b32 v12, 16, v15
    v_and_b32 v31, 0xffff0000, v15
    v_add_f32 v31, 0x3727c5ac, v31
    v_cvt_pk_bf16_f32 v15, v31, v31
    v_lshlrev_b32 v31, 16, v15
    v_sqrt_f32 v31, v31
    s_nop 0
    v_cvt_pk_bf16_f32 v15, v31, v31
    v_lshlrev_b32 v13, 16, v15
    v_rcp_f32 v14, v13
    s_nop 0
    s_branch L_wr_row
L_fb_s:
    v_cmp_lt_u32 vcc, 31, v1
    s_mov_b64 s[50:51], vcc
    v_and_b32 v92, 31, v1
    v_lshlrev_b32 v92, 3, v92
    s_lshl_b32 s46, s37, 8
    s_lshl_b32 s47, s41, 20
    s_add_u32 s46, s46, s47
    s_lshl_b32 s47, s41, 10
    v_mov_b32 v93, 0
    v_mov_b32 v16, 0
    v_mov_b32 v17, 0
    v_mov_b32 v18, 0
    v_mov_b32 v19, 0
    s_mov_b32 s52, 512
L_fb2:
    buffer_load_dwordx2 v[24:25], v92, s[20:23], s46 offen
    buffer_load_ushort v26, v93, s[24:27], s47 offen
    buffer_load_ushort v27, v93, s[28:31], s47 offen
    s_waitcnt vmcnt(0)
    v_cndmask_b32 v26, v26, v27, s[50:51]
    v_lshlrev_b32 v26, 16, v26
    v_lshlrev_b32 v28, 16, v24
    v_and_b32 v29, 0xffff0000, v24
    v_lshlrev_b32 v30, 16, v25
    v_and_b32 v31, 0xffff0000, v25
    v_fmac_f32 v16, v28, v26
    v_fmac_f32 v17, v29, v26
    v_fmac_f32 v18, v30, v26
    v_fmac_f32 v19, v31, v26
    s_add_u32 s46, s46, 2048
    s_add_u32 s47, s47, 2
    s_sub_u32 s52, s52, 1
    s_cmp_lg_u32 s52, 0
    s_cbranch_scc1 L_fb2
    s_branch L_wr_s
L_end:
    s_endpgm
.section .rodata,"a"
.p2align 6
.amdhsa_kernel standalone__layernorm_linear__sampling_kernel
  .amdhsa_next_free_vgpr 168
  .amdhsa_next_free_sgpr 96
  .amdhsa_accum_offset 104
  .amdhsa_group_segment_fixed_size 0
  .amdhsa_kernarg_size 56
  .amdhsa_user_sgpr_count 2
  .amdhsa_user_sgpr_kernarg_segment_ptr 1
  .amdhsa_system_sgpr_workgroup_id_x 1
.end_amdhsa_kernel
```
